```python
import torch

def _softmax(x, axis=-1):
    return torch.softmax(x, dim=axis)
def _gelu(x):
    return torch.nn.functional.gelu(x, approximate="tanh")
def _silu(x):
    return torch.nn.functional.silu(x)
def _sigmoid(x):
    return torch.sigmoid(x)
def _layernorm(x, axis=-1, eps=1e-5):
    m = x.mean(dim=axis, keepdim=True)
    v = x.var(dim=axis, keepdim=True, unbiased=False)
    return (x - m) / torch.sqrt(v + eps)
def _scatter_add(tgt, idx, src, axis=0):
    return tgt.clone().index_add_(axis, idx, src)
def _segment_sum(src, seg, n):
    out = torch.zeros((n,) + src.shape[1:], dtype=src.dtype)
    return out.index_add_(0, seg, src)
def _pad(x, pw):
    flat = tuple(v for pair in reversed(pw) for v in pair)
    return torch.nn.functional.pad(x, flat)

kernel_name = 'interleave_layers__ssm_conv_s4__swiglu_ffn__prompt'

def setup_inputs():

    _w = (lambda a: (lambda t: t.to(torch.bfloat16) if t.is_floating_point() else t)(torch.as_tensor(a)))
    def _A_setup():
        B, L, D, N = 1, 2048, 512, 128
        A_re = -(lambda _x: torch.exp(torch.as_tensor(_x)))((lambda *s: torch.randn(*s, dtype=torch.bfloat16) * 1.6)(D, N))
        A_im = torch.pi * (lambda *s: torch.randn(*s, dtype=torch.bfloat16) * 0.2)(D, N)
        B_re = (lambda *s: torch.randn(*s, dtype=torch.bfloat16) * 0.2)(D, N)
        B_im = (lambda *s: torch.randn(*s, dtype=torch.bfloat16) * 0.2)(D, N)
        C_re = (lambda *s: torch.randn(*s, dtype=torch.bfloat16) * 0.2)(D, N)
        C_im = (lambda *s: torch.randn(*s, dtype=torch.bfloat16) * 0.2)(D, N)
        log_dt = (lambda *s: torch.randn(*s, dtype=torch.bfloat16) * 0.2)(D) * 0.5 - 4.0
        Dskip = (lambda *s: torch.randn(*s, dtype=torch.bfloat16) * 0.2)(D)
        return {
            "u": _w((lambda *s: torch.randn(*s, dtype=torch.bfloat16) * 0.05)(B, L, D)),
            "A_re": _w(A_re),
            "A_im": _w(A_im),
            "B_re": _w(B_re),
            "B_im": _w(B_im),
            "C_re": _w(C_re),
            "C_im": _w(C_im),
            "log_dt": _w(log_dt),
            "Dskip": _w(Dskip),
        }
    _A_in = _A_setup()

    def _B_setup():
        B, S, D, F = 1, 2048, 512, 1376
        return {
            "x": _w((lambda *s: torch.randn(*s, dtype=torch.bfloat16) * 0.05)(B, S, D)),
            "w_gate": _w((lambda *s: torch.randn(*s, dtype=torch.bfloat16) * 0.05)(D, F)),
            "w_up": _w((lambda *s: torch.randn(*s, dtype=torch.bfloat16) * 0.05)(D, F)),
            "w_down": _w((lambda *s: torch.randn(*s, dtype=torch.bfloat16) * 0.05)(F, D)),
        }
    _B_in = _B_setup()

    return {
        "A_u": _A_in["u"],
        "A_A_re": _A_in["A_re"],
        "A_A_im": _A_in["A_im"],
        "A_B_re": _A_in["B_re"],
        "A_B_im": _A_in["B_im"],
        "A_C_re": _A_in["C_re"],
        "A_C_im": _A_in["C_im"],
        "A_log_dt": _A_in["log_dt"],
        "A_Dskip": _A_in["Dskip"],
        "B_x": _B_in["x"],
        "B_w_gate": _B_in["w_gate"],
        "B_w_up": _B_in["w_up"],
        "B_w_down": _B_in["w_down"],
    }

def reference(A_u, A_A_re, A_A_im, A_B_re, A_B_im, A_C_re, A_C_im, A_log_dt, A_Dskip, B_x, B_w_gate, B_w_up, B_w_down):
    def _A_ref(u, A_re, A_im, B_re, B_im, C_re, C_im, log_dt, Dskip):
        Bsz, L, D = u.shape
        dt = torch.exp(log_dt)[:, None]
        A = A_re + 1j * A_im
        Bc = B_re + 1j * B_im
        Cc = C_re + 1j * C_im
        logdA = dt * A
        dB = dt * Bc
        l = (lambda x, dt: x.to(dt))(torch.arange(L), A_re.dtype)
        P = torch.exp(logdA[:, :, None] * l[None, None, :])
        K = torch.einsum("dn,dnl,dn->dl", Cc, P, dB).real
        L2 = 2 * L
        Kp = _pad(K, ((0, 0), (0, L)))
        up = (lambda x, *d: x.permute(*d))(u, 0, 2, 1)
        up = _pad(up, ((0, 0), (0, 0), (0, L)))
        Kf = (lambda x, axes=(-2,-1): torch.fft.rfft2(x.float(), dim=axes))(Kp[:, None, :], axes=(-2, -1))
        Uf = (lambda x, axes=(-2,-1): torch.fft.rfft2(x.float(), dim=axes))(up[:, :, None, :], axes=(-2, -1))
        Yf = Uf * Kf[None, :, :, :]
        y = (lambda x, s, axes=(-2,-1): torch.fft.irfft2(x, s=s, dim=axes).to(torch.bfloat16))(Yf, (1, L2), axes=(-2, -1))[:, :, 0, :L]
        y = (lambda x, *d: x.permute(*d))(y, 0, 2, 1) + u * Dskip[None, None, :]
        return y

    def _B_ref(x, w_gate, w_up, w_down):
        g = _silu(x @ w_gate)
        u = x @ w_up
        return (g * u) @ w_down

    x = A_u
    x = x + _A_ref(_layernorm(x, axis=-1), A_A_re, A_A_im, A_B_re, A_B_im, A_C_re, A_C_im, A_log_dt, A_Dskip)
    x = x + _B_ref(_layernorm(x, axis=-1), B_w_gate, B_w_up, B_w_down)
    x = x + _A_ref(_layernorm(x, axis=-1), A_A_re, A_A_im, A_B_re, A_B_im, A_C_re, A_C_im, A_log_dt, A_Dskip)
    x = x + _B_ref(_layernorm(x, axis=-1), B_w_gate, B_w_up, B_w_down)
    return x
```

```asm
; @launch kernel=mega_kernel grid=(256,1,1) block=(512,1,1) lds=157696
.amdgcn_target "amdgcn-amd-amdhsa--gfx950"
.text
.globl mega_kernel
.p2align 8
.type mega_kernel,@function
mega_kernel:
    s_load_dwordx8 s[8:15], s[0:1], 8

    s_load_dwordx8 s[16:23], s[0:1], 40
    s_load_dwordx2 s[36:37], s[0:1], 0
    s_load_dwordx8 s[40:47], s[0:1], 80
    s_load_dwordx2 s[100:101], s[0:1], 112
    s_load_dwordx2 s[80:81], s[0:1], 120
    s_cmp_ge_u32 s2, 256
    s_cbranch_scc1 L_mega_end
    v_lshrrev_b32 v3, 6, v0
    v_and_b32 v1, 63, v0
    v_readfirstlane_b32 s70, v3
    v_mov_b32 v206, 8585216
    s_and_b32 s74, s2, 1
    s_lshl_b32 s74, s74, 3
    s_bfe_u32 s5, s2, 0x30003
    s_add_u32 s74, s74, s5
    s_bfe_u32 s75, s2, 0x20001
    s_lshl_b32 s75, s75, 2
    s_lshr_b32 s5, s2, 6
    s_add_u32 s75, s75, s5
    s_mov_b32 s64, 0
    s_mov_b32 s65, 0
    s_mov_b32 s66, 8388608
    s_mov_b32 s67, 2097152
    s_mov_b32 s68, 18874368
    s_mov_b32 s69, 8585216
    v_lshrrev_b32 v4, 8, v0
    v_and_b32 v2, 127, v0
    s_lshl_b32 s3, s2, 1
    v_add_u32 v3, s3, v4
    v_lshlrev_b32 v5, 7, v3
    v_add_u32 v5, v5, v2
    v_lshlrev_b32 v5, 1, v5
    v_lshlrev_b32 v3, 1, v3
    v_lshlrev_b32 v6, 11, v4
    v_lshl_add_u32 v6, v2, 4, v6
    v_add_u32 v6, 33792, v6
    s_mov_b32 s30, 0x3fb8aa3b
    s_mov_b32 s31, 0x3e22f983
    s_mov_b32 s50, 0
    s_cmp_lt_u32 s2, 236
    s_cselect_b32 s50, 3, s50
    s_cmp_lt_u32 s2, 150
    s_cselect_b32 s50, 2, s50
    s_cmp_lt_u32 s2, 64
    s_cselect_b32 s50, 1, s50
    s_waitcnt lgkmcnt(0)
    global_load_ushort v16, v3, s[20:21]
    global_load_ushort v10, v5, s[8:9]
    global_load_ushort v11, v5, s[10:11]
    global_load_ushort v12, v5, s[12:13]
    global_load_ushort v13, v5, s[14:15]
    global_load_ushort v14, v5, s[16:17]
    global_load_ushort v15, v5, s[18:19]
    s_lshl_b32 s11, s2, 2
    s_add_u32 s22, s22, s11
    s_addc_u32 s23, s23, 0
    s_load_dword s49, s[22:23], 0
    s_mov_b32 s24, s80
    s_mov_b32 s25, s81
    s_mov_b32 s26, 268435456
    s_mov_b32 s27, 0x00020000
    s_mov_b32 s76, s46
    s_mov_b32 s77, s47
    s_mov_b32 s78, 2097152
    s_mov_b32 s79, 0x00020000
    s_mov_b32 s52, s40
    s_mov_b32 s53, s41
    s_mov_b32 s54, 1409024
    s_mov_b32 s55, 0x00020000
    s_mov_b32 s56, s42
    s_mov_b32 s57, s43
    s_mov_b32 s58, 1409024
    s_mov_b32 s59, 0x00020000
    s_lshr_b32 s4, s2, 4
    s_and_b32 s5, s2, 15
    v_lshrrev_b32 v7, 4, v0
    v_and_b32 v8, 15, v0
    s_lshl_b32 s6, s5, 5
    v_add_u32 v9, s6, v7
    s_movk_i32 s7, 2752
    v_mul_lo_u32 v9, v9, s7
    s_mul_i32 s6, s4, 192
    v_lshl_add_u32 v9, v8, 4, v9
    v_add_u32 v9, s6, v9
    buffer_load_dwordx4 v[100:103], v9, s[52:55], 0 offen
    buffer_load_dwordx4 v[104:107], v9, s[56:59], 0 offen
    v_mul_u32_u24 v98, 272, v7
    v_lshl_add_u32 v98, v8, 4, v98
    v_add_u32 v98, 66816, v98
    s_cmp_eq_u32 s50, 1
    s_cbranch_scc1 L_pp_xpl
    s_cmp_eq_u32 s50, 2
    s_cbranch_scc1 L_pp_wdl
    s_cmp_eq_u32 s50, 3
    s_cbranch_scc1 L_pp_csl
    s_cmp_lg_u32 s2, 255
    s_cbranch_scc1 L_pp_ldone
    v_mov_b32 v108, 0
    v_mov_b32 v109, 0
    v_mov_b32 v110, 0
    v_mov_b32 v111, 0
    v_lshlrev_b32 v7, 4, v0
    s_mov_b32 s6, 8585216
    s_mov_b32 s7, 8454144
    buffer_store_dwordx4 v[108:111], v7, s[24:27], s6 offen sc1
    s_add_u32 s6, s6, 8192
    buffer_store_dwordx4 v[108:111], v7, s[24:27], s6 offen sc1
    s_add_u32 s6, s6, 8192
    buffer_store_dwordx4 v[108:111], v7, s[24:27], s6 offen sc1
    s_add_u32 s6, s6, 8192
    buffer_store_dwordx4 v[108:111], v7, s[24:27], s6 offen sc1
    s_add_u32 s6, s6, 8192
    buffer_store_dwordx4 v[108:111], v7, s[24:27], s7 offen sc1
    s_add_u32 s7, s7, 8192
    buffer_store_dwordx4 v[108:111], v7, s[24:27], s7 offen sc1
    s_add_u32 s7, s7, 8192
    s_waitcnt vmcnt(0)
    s_barrier
    v_mov_b32 v7, 0
    v_mov_b32 v8, 1
    s_mov_b64 exec, 1
    global_store_dword v7, v8, s[100:101] sc1
    s_mov_b64 exec, -1
    s_branch L_pp_ldone
L_pp_xpl:
    s_lshl_b32 s6, s2, 15
    v_lshrrev_b32 v7, 6, v0
    v_lshlrev_b32 v7, 12, v7
    v_lshl_add_u32 v7, v1, 4, v7
    v_add_u32 v7, s6, v7
    global_load_dwordx4 v[108:111], v7, s[36:37] offset:0
    global_load_dwordx4 v[112:115], v7, s[36:37] offset:1024
    global_load_dwordx4 v[116:119], v7, s[36:37] offset:2048
    global_load_dwordx4 v[120:123], v7, s[36:37] offset:3072
    s_branch L_pp_ldone
L_pp_wdl:
    s_sub_u32 s51, s2, 64
    s_lshr_b32 s6, s51, 1
    s_lshl_b32 s6, s6, 15
    s_and_b32 s7, s51, 1
    s_lshl_b32 s7, s7, 9
    s_add_u32 s6, s6, s7
    v_lshrrev_b32 v7, 5, v0
    v_and_b32 v8, 31, v0
    v_lshlrev_b32 v9, 10, v7
    v_lshl_add_u32 v9, v8, 4, v9
    v_add_u32 v9, s6, v9
    v_add_u32 v7, 16384, v9
    global_load_dwordx4 v[108:111], v9, s[44:45]
    global_load_dwordx4 v[112:115], v7, s[44:45]
    s_branch L_pp_ldone
L_pp_csl:
    s_sub_u32 s51, s2, 150
    s_movk_i32 s7, 2752
    v_lshrrev_b32 v7, 4, v0
    v_mul_lo_u32 v7, v7, s7
    v_and_b32 v8, 15, v0
    v_lshl_add_u32 v7, v8, 2, v7
    s_lshr_b32 s6, s51, 1
    s_lshl_b32 s6, s6, 6
    s_bitcmp1_b32 s51, 0
    s_cbranch_scc1 L_pp_csu
    buffer_load_dword v128, v7, s[52:55], s6 offen
    s_add_u32 s6, s6, 88064
    buffer_load_dword v129, v7, s[52:55], s6 offen
    s_add_u32 s6, s6, 88064
    buffer_load_dword v130, v7, s[52:55], s6 offen
    s_add_u32 s6, s6, 88064
    buffer_load_dword v131, v7, s[52:55], s6 offen
    s_add_u32 s6, s6, 88064
    buffer_load_dword v132, v7, s[52:55], s6 offen
    s_add_u32 s6, s6, 88064
    buffer_load_dword v133, v7, s[52:55], s6 offen
    s_add_u32 s6, s6, 88064
    buffer_load_dword v134, v7, s[52:55], s6 offen
    s_add_u32 s6, s6, 88064
    buffer_load_dword v135, v7, s[52:55], s6 offen
    s_add_u32 s6, s6, 88064
    buffer_load_dword v136, v7, s[52:55], s6 offen
    s_add_u32 s6, s6, 88064
    buffer_load_dword v137, v7, s[52:55], s6 offen
    s_add_u32 s6, s6, 88064
    buffer_load_dword v138, v7, s[52:55], s6 offen
    s_add_u32 s6, s6, 88064
    buffer_load_dword v139, v7, s[52:55], s6 offen
    s_add_u32 s6, s6, 88064
    buffer_load_dword v140, v7, s[52:55], s6 offen
    s_add_u32 s6, s6, 88064
    buffer_load_dword v141, v7, s[52:55], s6 offen
    s_add_u32 s6, s6, 88064
    buffer_load_dword v142, v7, s[52:55], s6 offen
    s_add_u32 s6, s6, 88064
    buffer_load_dword v143, v7, s[52:55], s6 offen
    s_add_u32 s6, s6, 88064
    s_branch L_pp_ldone
L_pp_csu:
    buffer_load_dword v128, v7, s[56:59], s6 offen
    s_add_u32 s6, s6, 88064
    buffer_load_dword v129, v7, s[56:59], s6 offen
    s_add_u32 s6, s6, 88064
    buffer_load_dword v130, v7, s[56:59], s6 offen
    s_add_u32 s6, s6, 88064
    buffer_load_dword v131, v7, s[56:59], s6 offen
    s_add_u32 s6, s6, 88064
    buffer_load_dword v132, v7, s[56:59], s6 offen
    s_add_u32 s6, s6, 88064
    buffer_load_dword v133, v7, s[56:59], s6 offen
    s_add_u32 s6, s6, 88064
    buffer_load_dword v134, v7, s[56:59], s6 offen
    s_add_u32 s6, s6, 88064
    buffer_load_dword v135, v7, s[56:59], s6 offen
    s_add_u32 s6, s6, 88064
    buffer_load_dword v136, v7, s[56:59], s6 offen
    s_add_u32 s6, s6, 88064
    buffer_load_dword v137, v7, s[56:59], s6 offen
    s_add_u32 s6, s6, 88064
    buffer_load_dword v138, v7, s[56:59], s6 offen
    s_add_u32 s6, s6, 88064
    buffer_load_dword v139, v7, s[56:59], s6 offen
    s_add_u32 s6, s6, 88064
    buffer_load_dword v140, v7, s[56:59], s6 offen
    s_add_u32 s6, s6, 88064
    buffer_load_dword v141, v7, s[56:59], s6 offen
    s_add_u32 s6, s6, 88064
    buffer_load_dword v142, v7, s[56:59], s6 offen
    s_add_u32 s6, s6, 88064
    buffer_load_dword v143, v7, s[56:59], s6 offen
    s_add_u32 s6, s6, 88064
L_pp_ldone:
    v_and_b32 v2, 15, v0
    v_lshrrev_b32 v3, 4, v1
    v_lshrrev_b32 v4, 6, v0
    v_lshlrev_b32 v5, 3, v2
    v_cvt_f32_u32 v40, v5
    v_lshrrev_b32 v5, 3, v2
    v_lshlrev_b32 v5, 7, v5
    v_and_b32 v7, 7, v2
    v_add_u32 v5, v5, v7
    v_cvt_f32_u32 v41, v5
    v_lshrrev_b32 v5, 2, v2
    v_lshlrev_b32 v5, 7, v5
    v_and_b32 v7, 3, v2
    v_lshl_add_u32 v5, v7, 1, v5
    v_add_u32 v5, 256, v5
    v_subrev_u32 v7, 8, v2
    v_lshrrev_b32 v7, 1, v7
    v_lshlrev_b32 v7, 7, v7
    v_and_b32 v8, 1, v2
    v_lshl_add_u32 v7, v8, 2, v7
    v_add_u32 v7, 512, v7
    v_cmp_gt_u32 vcc, 8, v2
    v_lshlrev_b32 v8, 7, v2
    v_add_u32 v8, 1024, v8
    v_cndmask_b32 v5, v7, v5, vcc
    v_cvt_f32_u32 v42, v5
    v_cvt_f32_u32 v43, v8
    v_lshrrev_b32 v5, 2, v4
    v_lshlrev_b32 v5, 11, v5
    v_and_b32 v7, 3, v4
    v_lshl_add_u32 v5, v7, 9, v5
    v_lshl_add_u32 v44, v3, 6, v5
    v_add_u32 v44, 33792, v44
    s_cmp_eq_u32 s50, 3
    s_cbranch_scc1 L_pp_w3
    s_waitcnt vmcnt(0)
    s_branch L_pp_w
L_pp_w3:
    s_waitcnt vmcnt(16)
L_pp_w:

    v_lshlrev_b32 v16, 16, v16
    v_mul_f32 v16, s30, v16
    v_exp_f32 v16, v16
    v_lshlrev_b32 v10, 16, v10
    v_lshlrev_b32 v11, 16, v11
    v_lshlrev_b32 v12, 16, v12
    v_lshlrev_b32 v13, 16, v13
    v_lshlrev_b32 v14, 16, v14
    v_lshlrev_b32 v15, 16, v15
    v_cvt_pk_bf16_f32 v16, v16, v16
    v_lshlrev_b32 v16, 16, v16
    v_mul_f32 v20, v16, v10
    v_mul_f32 v20, s30, v20
    v_mul_f32 v21, v16, v11
    v_mul_f32 v21, s31, v21
    v_mul_f32 v12, v16, v12
    v_mul_f32 v13, v16, v13
    v_mul_f32 v22, v14, v12
    v_fma_f32 v22, -v15, v13, v22
    v_mul_f32 v23, v14, v13
    v_fma_f32 v23, v15, v12, v23
    ds_write_b128 v6, v[20:23]
    v_max_f32 v24, abs(v22), abs(v23)
    v_mov_b32 v25, v20
    s_nop 0
    v_max_f32 v24, v24, v24 quad_perm:[1,0,3,2]
    v_max_f32 v25, v25, v25 quad_perm:[1,0,3,2]
    s_nop 0
    v_max_f32 v24, v24, v24 quad_perm:[2,3,0,1]
    v_max_f32 v25, v25, v25 quad_perm:[2,3,0,1]
    s_nop 0
    v_max_f32 v24, v24, v24 row_half_mirror
    v_max_f32 v25, v25, v25 row_half_mirror
    s_nop 0
    v_max_f32 v24, v24, v24 row_mirror
    v_max_f32 v25, v25, v25 row_mirror
    v_lshrrev_b32 v26, 4, v0
    v_lshlrev_b32 v26, 3, v26
    v_add_u32 v26, 62592, v26
    ds_write_b64 v26, v[24:25]
    ds_write_b128 v98, v[100:103]
    ds_write_b128 v98, v[104:107] offset:8704
    s_cmp_eq_u32 s50, 2
    s_cbranch_scc1 L_pp_wdw
    s_cmp_lg_u32 s50, 1
    s_cbranch_scc1 L_pp_b1
    v_mul_u32_u24 v7, 4224, v4
    v_lshl_add_u32 v7, v1, 4, v7
    v_add_u32 v7, 84224, v7
    s_mov_b32 s5, 0x3f803f80
    ds_write_b128 v7, v[108:111] offset:0
    v_dot2_f32_bf16 v48, v108, s5, 0
    v_dot2_f32_bf16 v52, v108, v108, 0
    v_dot2_f32_bf16 v48, v109, s5, v48
    v_dot2_f32_bf16 v52, v109, v109, v52
    v_dot2_f32_bf16 v48, v110, s5, v48
    v_dot2_f32_bf16 v52, v110, v110, v52
    v_dot2_f32_bf16 v48, v111, s5, v48
    v_dot2_f32_bf16 v52, v111, v111, v52
    ds_write_b128 v7, v[112:115] offset:1056
    v_dot2_f32_bf16 v49, v112, s5, 0
    v_dot2_f32_bf16 v53, v112, v112, 0
    v_dot2_f32_bf16 v49, v113, s5, v49
    v_dot2_f32_bf16 v53, v113, v113, v53
    v_dot2_f32_bf16 v49, v114, s5, v49
    v_dot2_f32_bf16 v53, v114, v114, v53
    v_dot2_f32_bf16 v49, v115, s5, v49
    v_dot2_f32_bf16 v53, v115, v115, v53
    ds_write_b128 v7, v[116:119] offset:2112
    v_dot2_f32_bf16 v50, v116, s5, 0
    v_dot2_f32_bf16 v54, v116, v116, 0
    v_dot2_f32_bf16 v50, v117, s5, v50
    v_dot2_f32_bf16 v54, v117, v117, v54
    v_dot2_f32_bf16 v50, v118, s5, v50
    v_dot2_f32_bf16 v54, v118, v118, v54
    v_dot2_f32_bf16 v50, v119, s5, v50
    v_dot2_f32_bf16 v54, v119, v119, v54
    ds_write_b128 v7, v[120:123] offset:3168
    v_dot2_f32_bf16 v51, v120, s5, 0
    v_dot2_f32_bf16 v55, v120, v120, 0
    v_dot2_f32_bf16 v51, v121, s5, v51
    v_dot2_f32_bf16 v55, v121, v121, v55
    v_dot2_f32_bf16 v51, v122, s5, v51
    v_dot2_f32_bf16 v55, v122, v122, v55
    v_dot2_f32_bf16 v51, v123, s5, v51
    v_dot2_f32_bf16 v55, v123, v123, v55
    v_permlane32_swap_b32 v48, v52
    v_permlane32_swap_b32 v49, v53
    v_permlane32_swap_b32 v50, v54
    v_permlane32_swap_b32 v51, v55
    v_add_f32 v48, v48, v52
    v_add_f32 v49, v49, v53
    v_add_f32 v50, v50, v54
    v_add_f32 v51, v51, v55
    s_nop 0
    v_permlane16_swap_b32 v48, v50
    v_permlane16_swap_b32 v49, v51
    v_add_f32 v48, v48, v50
    v_add_f32 v49, v49, v51
    s_nop 0
    v_add_f32 v48, v48, v48 quad_perm:[1,0,3,2]
    v_add_f32 v49, v49, v49 quad_perm:[1,0,3,2]
    s_nop 0
    v_add_f32 v48, v48, v48 quad_perm:[2,3,0,1]
    v_add_f32 v49, v49, v49 quad_perm:[2,3,0,1]
    s_nop 0
    v_add_f32 v48, v48, v48 row_half_mirror
    v_add_f32 v49, v49, v49 row_half_mirror
    s_nop 0
    v_add_f32 v48, v48, v48 row_mirror
    v_add_f32 v49, v49, v49 row_mirror
    v_and_b32 v8, 1, v1
    v_cmp_eq_u32 vcc, 1, v8
    v_bfe_u32 v9, v1, 4, 1
    v_lshl_add_u32 v8, v9, 1, v8
    v_cndmask_b32 v48, v48, v49, vcc
    v_lshl_add_u32 v8, v4, 2, v8
    s_lshl_b32 s5, s2, 5
    v_add_u32 v8, s5, v8
    v_lshlrev_b32 v8, 2, v8
    v_lshrrev_b32 v9, 5, v1
    v_lshl_add_u32 v8, v9, 13, v8
    v_cmp_gt_u32 vcc, 2, v2
    s_mov_b32 s5, 8388608
    s_and_saveexec_b64 s[10:11], vcc
    buffer_store_dword v48, v8, s[24:27], s5 offen sc1
    s_mov_b64 exec, s[10:11]
    s_branch L_pp_b1
L_pp_wdw:
    v_lshrrev_b32 v7, 5, v0
    v_and_b32 v8, 31, v0
    v_mul_u32_u24 v7, 528, v7
    v_lshl_add_u32 v7, v8, 4, v7
    v_add_u32 v7, 84224, v7
    ds_write_b128 v7, v[108:111]
    ds_write_b128 v7, v[112:115] offset:8448
L_pp_b1:
    s_waitcnt lgkmcnt(0)
    s_barrier

    s_cmp_lg_u32 s50, 1
    s_cbranch_scc1 L_pp_bdone
    v_bfe_u32 v9, v1, 2, 2
    v_lshl_add_u32 v9, v3, 3, v9
    v_mul_u32_u24 v9, 1056, v9
    v_and_b32 v10, 3, v1
    v_lshl_add_u32 v9, v10, 3, v9
    v_lshl_add_u32 v9, v4, 7, v9
    v_add_u32 v9, 84224, v9
    v_lshl_add_u32 v10, v4, 6, v2
    v_lshlrev_b32 v10, 12, v10
    v_lshl_add_u32 v10, v3, 4, v10
    s_lshl_b32 s5, s2, 6
    v_add_u32 v10, s5, v10
    ds_read_b64_tr_b16 v[100:101], v9 offset:0
    ds_read_b64_tr_b16 v[102:103], v9 offset:4224
    ds_read_b64_tr_b16 v[104:105], v9 offset:32
    ds_read_b64_tr_b16 v[106:107], v9 offset:4256
    ds_read_b64_tr_b16 v[108:109], v9 offset:64
    ds_read_b64_tr_b16 v[110:111], v9 offset:4288
    ds_read_b64_tr_b16 v[112:113], v9 offset:96
    ds_read_b64_tr_b16 v[114:115], v9 offset:4320
    s_mov_b32 s5, 0
    s_waitcnt lgkmcnt(6)
    buffer_store_dwordx4 v[100:103], v10, s[24:27], s5 offen sc1
    s_mov_b32 s5, 65536
    s_waitcnt lgkmcnt(4)
    buffer_store_dwordx4 v[104:107], v10, s[24:27], s5 offen sc1
    s_mov_b32 s5, 131072
    s_waitcnt lgkmcnt(2)
    buffer_store_dwordx4 v[108:111], v10, s[24:27], s5 offen sc1
    s_mov_b32 s5, 196608
    s_waitcnt lgkmcnt(0)
    buffer_store_dwordx4 v[112:115], v10, s[24:27], s5 offen sc1

L_pp_bdone:

    v_lshrrev_b32 v8, 8, v0
    v_lshlrev_b32 v8, 7, v8
    v_add_u32 v8, 62592, v8
    ds_read_b128 v[12:15], v8
    ds_read_b128 v[16:19], v8 offset:16
    ds_read_b128 v[20:23], v8 offset:32
    ds_read_b128 v[24:27], v8 offset:48
    s_mov_b32 s4, 0
    s_waitcnt lgkmcnt(0)
    v_max3_f32 v12, v12, v14, v16
    v_max3_f32 v13, v13, v15, v17
    v_max3_f32 v18, v18, v20, v22
    v_max3_f32 v19, v19, v21, v23
    v_max3_f32 v12, v12, v24, v26
    v_max3_f32 v13, v13, v25, v27
    v_max_f32 v12, v12, v18
    v_max_f32 v13, v13, v19
    v_readfirstlane_b32 s38, v12
    v_readfirstlane_b32 s39, v13
    s_lshr_b32 s38, s38, 23
    s_max_u32 s38, s38, 40
    s_min_u32 s38, s38, 240
    s_sub_u32 s38, 140, s38
    s_add_u32 s48, s38, 127
    s_lshl_b32 s48, s48, 23
    s_cmp_gt_i32 s39, 0
    s_cbranch_scc1 L_pp_slow
L_pp_floop:
    ds_read_b128 v[8:11], v44
    ds_read_b128 v[12:15], v44 offset:16
    ds_read_b128 v[16:19], v44 offset:32
    ds_read_b128 v[20:23], v44 offset:48
    v_add_u32 v44, 256, v44
    s_waitcnt lgkmcnt(0)
    v_mul_f32 v24, v8, v40
    v_mul_f32 v28, v9, v40
    v_mul_f32 v25, v12, v40
    v_mul_f32 v29, v13, v40
    v_mul_f32 v26, v16, v40
    v_mul_f32 v30, v17, v40
    v_mul_f32 v27, v20, v40
    v_mul_f32 v31, v21, v40
    v_exp_f32 v24, v24
    v_fract_f32 v28, v28
    v_exp_f32 v25, v25
    v_fract_f32 v29, v29
    v_exp_f32 v26, v26
    v_fract_f32 v30, v30
    v_exp_f32 v27, v27
    v_fract_f32 v31, v31
    v_cos_f32 v32, v28
    v_sin_f32 v28, v28
    v_cos_f32 v33, v29
    v_sin_f32 v29, v29
    v_cos_f32 v34, v30
    v_sin_f32 v30, v30
    v_cos_f32 v35, v31
    v_sin_f32 v31, v31
    v_mul_f32 v24, s48, v24
    v_mul_f32 v36, v10, v32
    v_mul_f32 v37, v10, v28
    v_fma_f32 v36, -v11, v28, v36
    v_fma_f32 v37, v11, v32, v37
    v_mul_f32 v32, v24, v36
    v_mul_f32 v28, -v24, v37
    v_mul_f32 v25, s48, v25
    v_mul_f32 v36, v14, v33
    v_mul_f32 v37, v14, v29
    v_fma_f32 v36, -v15, v29, v36
    v_fma_f32 v37, v15, v33, v37
    v_mul_f32 v33, v25, v36
    v_mul_f32 v29, -v25, v37
    v_mul_f32 v26, s48, v26
    v_mul_f32 v36, v18, v34
    v_mul_f32 v37, v18, v30
    v_fma_f32 v36, -v19, v30, v36
    v_fma_f32 v37, v19, v34, v37
    v_mul_f32 v34, v26, v36
    v_mul_f32 v30, -v26, v37
    v_mul_f32 v27, s48, v27
    v_mul_f32 v36, v22, v35
    v_mul_f32 v37, v22, v31
    v_fma_f32 v36, -v23, v31, v36
    v_fma_f32 v37, v23, v35, v37
    v_mul_f32 v35, v27, v36
    v_mul_f32 v31, -v27, v37
    v_cvt_pk_f16_f32 v60, v32, v28
    v_cvt_pk_f16_f32 v61, v33, v29
    v_cvt_pk_f16_f32 v62, v34, v30
    v_cvt_pk_f16_f32 v63, v35, v31
    s_cmp_eq_u32 s4, 0
    s_cbranch_scc0 L_pp_facc
    v_mov_b32 v48, 0
    v_mov_b32 v49, 0
    v_mov_b32 v50, 0
    v_mov_b32 v51, 0
    v_mov_b32 v52, 0
    v_mov_b32 v53, 0
    v_mov_b32 v54, 0
    v_mov_b32 v55, 0
    v_mov_b32 v56, 0
    v_mov_b32 v57, 0
    v_mov_b32 v58, 0
    v_mov_b32 v59, 0
L_pp_facc:
    v_mul_f32 v24, v8, v41
    v_mul_f32 v28, v9, v41
    v_mul_f32 v25, v12, v41
    v_mul_f32 v29, v13, v41
    v_mul_f32 v26, v16, v41
    v_mul_f32 v30, v17, v41
    v_mul_f32 v27, v20, v41
    v_mul_f32 v31, v21, v41
    v_exp_f32 v24, v24
    v_fract_f32 v28, v28
    v_exp_f32 v25, v25
    v_fract_f32 v29, v29
    v_exp_f32 v26, v26
    v_fract_f32 v30, v30
    v_exp_f32 v27, v27
    v_fract_f32 v31, v31
    v_cos_f32 v32, v28
    v_sin_f32 v28, v28
    v_cos_f32 v33, v29
    v_sin_f32 v29, v29
    v_cos_f32 v34, v30
    v_sin_f32 v30, v30
    v_cos_f32 v35, v31
    v_sin_f32 v31, v31
    v_mul_f32 v32, v24, v32
    v_mul_f32 v28, v24, v28
    v_mul_f32 v33, v25, v33
    v_mul_f32 v29, v25, v29
    v_mul_f32 v34, v26, v34
    v_mul_f32 v30, v26, v30
    v_mul_f32 v35, v27, v35
    v_mul_f32 v31, v27, v31
    v_cvt_pk_f16_f32 v68, v32, v28
    v_cvt_pk_f16_f32 v69, v33, v29
    v_cvt_pk_f16_f32 v70, v34, v30
    v_cvt_pk_f16_f32 v71, v35, v31
    s_nop 1
    v_mfma_f32_16x16x32_f16 v[48:51], v[68:71], v[60:63], v[48:51]
    v_mul_f32 v24, v8, v42
    v_mul_f32 v28, v9, v42
    v_mul_f32 v25, v12, v42
    v_mul_f32 v29, v13, v42
    v_mul_f32 v26, v16, v42
    v_mul_f32 v30, v17, v42
    v_mul_f32 v27, v20, v42
    v_mul_f32 v31, v21, v42
    v_exp_f32 v24, v24
    v_fract_f32 v28, v28
    v_exp_f32 v25, v25
    v_fract_f32 v29, v29
    v_exp_f32 v26, v26
    v_fract_f32 v30, v30
    v_exp_f32 v27, v27
    v_fract_f32 v31, v31
    v_cos_f32 v32, v28
    v_sin_f32 v28, v28
    v_cos_f32 v33, v29
    v_sin_f32 v29, v29
    v_cos_f32 v34, v30
    v_sin_f32 v30, v30
    v_cos_f32 v35, v31
    v_sin_f32 v31, v31
    v_mul_f32 v32, v24, v32
    v_mul_f32 v28, v24, v28
    v_mul_f32 v33, v25, v33
    v_mul_f32 v29, v25, v29
    v_mul_f32 v34, v26, v34
    v_mul_f32 v30, v26, v30
    v_mul_f32 v35, v27, v35
    v_mul_f32 v31, v27, v31
    v_cvt_pk_f16_f32 v68, v32, v28
    v_cvt_pk_f16_f32 v69, v33, v29
    v_cvt_pk_f16_f32 v70, v34, v30
    v_cvt_pk_f16_f32 v71, v35, v31
    s_nop 1
    v_mfma_f32_16x16x32_f16 v[52:55], v[68:71], v[60:63], v[52:55]
    v_mul_f32 v24, v8, v43
    v_mul_f32 v28, v9, v43
    v_mul_f32 v25, v12, v43
    v_mul_f32 v29, v13, v43
    v_mul_f32 v26, v16, v43
    v_mul_f32 v30, v17, v43
    v_mul_f32 v27, v20, v43
    v_mul_f32 v31, v21, v43
    v_exp_f32 v24, v24
    v_fract_f32 v28, v28
    v_exp_f32 v25, v25
    v_fract_f32 v29, v29
    v_exp_f32 v26, v26
    v_fract_f32 v30, v30
    v_exp_f32 v27, v27
    v_fract_f32 v31, v31
    v_cos_f32 v32, v28
    v_sin_f32 v28, v28
    v_cos_f32 v33, v29
    v_sin_f32 v29, v29
    v_cos_f32 v34, v30
    v_sin_f32 v30, v30
    v_cos_f32 v35, v31
    v_sin_f32 v31, v31
    v_mul_f32 v32, v24, v32
    v_mul_f32 v28, v24, v28
    v_mul_f32 v33, v25, v33
    v_mul_f32 v29, v25, v29
    v_mul_f32 v34, v26, v34
    v_mul_f32 v30, v26, v30
    v_mul_f32 v35, v27, v35
    v_mul_f32 v31, v27, v31
    v_cvt_pk_f16_f32 v68, v32, v28
    v_cvt_pk_f16_f32 v69, v33, v29
    v_cvt_pk_f16_f32 v70, v34, v30
    v_cvt_pk_f16_f32 v71, v35, v31
    s_nop 1
    v_mfma_f32_16x16x32_f16 v[56:59], v[68:71], v[60:63], v[56:59]
    s_add_u32 s4, s4, 1
    s_cmp_lt_u32 s4, 2
    s_cbranch_scc1 L_pp_floop
    s_branch L_pp_ldn
L_pp_slow:
    s_mov_b32 s38, 0
L_pp_loop:
    ds_read_b128 v[8:11], v44
    ds_read_b128 v[12:15], v44 offset:16
    ds_read_b128 v[16:19], v44 offset:32
    ds_read_b128 v[20:23], v44 offset:48
    v_add_u32 v44, 256, v44
    s_waitcnt lgkmcnt(0)
    v_mul_f32 v24, v8, v40
    v_mul_f32 v28, v9, v40
    v_mul_f32 v25, v12, v40
    v_mul_f32 v29, v13, v40
    v_mul_f32 v26, v16, v40
    v_mul_f32 v30, v17, v40
    v_mul_f32 v27, v20, v40
    v_mul_f32 v31, v21, v40
    v_exp_f32 v24, v24
    v_fract_f32 v28, v28
    v_exp_f32 v25, v25
    v_fract_f32 v29, v29
    v_exp_f32 v26, v26
    v_fract_f32 v30, v30
    v_exp_f32 v27, v27
    v_fract_f32 v31, v31
    v_cos_f32 v32, v28
    v_sin_f32 v28, v28
    v_cos_f32 v33, v29
    v_sin_f32 v29, v29
    v_cos_f32 v34, v30
    v_sin_f32 v30, v30
    v_cos_f32 v35, v31
    v_sin_f32 v31, v31
    v_mul_f32 v36, v10, v32
    v_mul_f32 v37, v10, v28
    v_fma_f32 v36, -v11, v28, v36
    v_fma_f32 v37, v11, v32, v37
    v_mul_f32 v32, v24, v36
    v_mul_f32 v28, -v24, v37
    v_mul_f32 v36, v14, v33
    v_mul_f32 v37, v14, v29
    v_fma_f32 v36, -v15, v29, v36
    v_fma_f32 v37, v15, v33, v37
    v_mul_f32 v33, v25, v36
    v_mul_f32 v29, -v25, v37
    v_mul_f32 v36, v18, v34
    v_mul_f32 v37, v18, v30
    v_fma_f32 v36, -v19, v30, v36
    v_fma_f32 v37, v19, v34, v37
    v_mul_f32 v34, v26, v36
    v_mul_f32 v30, -v26, v37
    v_mul_f32 v36, v22, v35
    v_mul_f32 v37, v22, v31
    v_fma_f32 v36, -v23, v31, v36
    v_fma_f32 v37, v23, v35, v37
    v_mul_f32 v35, v27, v36
    v_mul_f32 v31, -v27, v37
    v_cvt_pk_bf16_f32 v60, v32, v28
    v_cvt_pk_bf16_f32 v61, v33, v29
    v_cvt_pk_bf16_f32 v62, v34, v30
    v_cvt_pk_bf16_f32 v63, v35, v31
    v_lshlrev_b32 v24, 16, v60
    v_and_b32 v64, 0xffff0000, v60
    v_lshlrev_b32 v25, 16, v61
    v_and_b32 v65, 0xffff0000, v61
    v_lshlrev_b32 v26, 16, v62
    v_and_b32 v66, 0xffff0000, v62
    v_lshlrev_b32 v27, 16, v63
    v_and_b32 v67, 0xffff0000, v63
    v_sub_f32 v32, v32, v24
    v_sub_f32 v28, v28, v64
    v_sub_f32 v33, v33, v25
    v_sub_f32 v29, v29, v65
    v_sub_f32 v34, v34, v26
    v_sub_f32 v30, v30, v66
    v_sub_f32 v35, v35, v27
    v_sub_f32 v31, v31, v67
    v_cvt_pk_bf16_f32 v64, v32, v28
    v_cvt_pk_bf16_f32 v65, v33, v29
    v_cvt_pk_bf16_f32 v66, v34, v30
    v_cvt_pk_bf16_f32 v67, v35, v31
    s_cmp_eq_u32 s4, 0
    s_cbranch_scc0 L_pp_acc
    v_mov_b32 v48, 0
    v_mov_b32 v49, 0
    v_mov_b32 v50, 0
    v_mov_b32 v51, 0
    v_mov_b32 v52, 0
    v_mov_b32 v53, 0
    v_mov_b32 v54, 0
    v_mov_b32 v55, 0
    v_mov_b32 v56, 0
    v_mov_b32 v57, 0
    v_mov_b32 v58, 0
    v_mov_b32 v59, 0
L_pp_acc:
    v_mul_f32 v24, v8, v41
    v_mul_f32 v28, v9, v41
    v_mul_f32 v25, v12, v41
    v_mul_f32 v29, v13, v41
    v_mul_f32 v26, v16, v41
    v_mul_f32 v30, v17, v41
    v_mul_f32 v27, v20, v41
    v_mul_f32 v31, v21, v41
    v_exp_f32 v24, v24
    v_fract_f32 v28, v28
    v_exp_f32 v25, v25
    v_fract_f32 v29, v29
    v_exp_f32 v26, v26
    v_fract_f32 v30, v30
    v_exp_f32 v27, v27
    v_fract_f32 v31, v31
    v_cos_f32 v32, v28
    v_sin_f32 v28, v28
    v_cos_f32 v33, v29
    v_sin_f32 v29, v29
    v_cos_f32 v34, v30
    v_sin_f32 v30, v30
    v_cos_f32 v35, v31
    v_sin_f32 v31, v31
    v_mul_f32 v32, v24, v32
    v_mul_f32 v28, v24, v28
    v_mul_f32 v33, v25, v33
    v_mul_f32 v29, v25, v29
    v_mul_f32 v34, v26, v34
    v_mul_f32 v30, v26, v30
    v_mul_f32 v35, v27, v35
    v_mul_f32 v31, v27, v31
    v_cvt_pk_bf16_f32 v68, v32, v28
    v_cvt_pk_bf16_f32 v69, v33, v29
    v_cvt_pk_bf16_f32 v70, v34, v30
    v_cvt_pk_bf16_f32 v71, v35, v31
    v_lshlrev_b32 v24, 16, v68
    v_and_b32 v72, 0xffff0000, v68
    v_lshlrev_b32 v25, 16, v69
    v_and_b32 v73, 0xffff0000, v69
    v_lshlrev_b32 v26, 16, v70
    v_and_b32 v74, 0xffff0000, v70
    v_lshlrev_b32 v27, 16, v71
    v_and_b32 v75, 0xffff0000, v71
    v_sub_f32 v32, v32, v24
    v_sub_f32 v28, v28, v72
    v_sub_f32 v33, v33, v25
    v_sub_f32 v29, v29, v73
    v_sub_f32 v34, v34, v26
    v_sub_f32 v30, v30, v74
    v_sub_f32 v35, v35, v27
    v_sub_f32 v31, v31, v75
    v_cvt_pk_bf16_f32 v72, v32, v28
    v_cvt_pk_bf16_f32 v73, v33, v29
    v_cvt_pk_bf16_f32 v74, v34, v30
    v_cvt_pk_bf16_f32 v75, v35, v31
    v_mfma_f32_16x16x32_bf16 v[48:51], v[68:71], v[60:63], v[48:51]
    v_mfma_f32_16x16x32_bf16 v[48:51], v[68:71], v[64:67], v[48:51]
    v_mfma_f32_16x16x32_bf16 v[48:51], v[72:75], v[60:63], v[48:51]
    v_mul_f32 v24, v8, v42
    v_mul_f32 v28, v9, v42
    v_mul_f32 v25, v12, v42
    v_mul_f32 v29, v13, v42
    v_mul_f32 v26, v16, v42
    v_mul_f32 v30, v17, v42
    v_mul_f32 v27, v20, v42
    v_mul_f32 v31, v21, v42
    v_exp_f32 v24, v24
    v_fract_f32 v28, v28
    v_exp_f32 v25, v25
    v_fract_f32 v29, v29
    v_exp_f32 v26, v26
    v_fract_f32 v30, v30
    v_exp_f32 v27, v27
    v_fract_f32 v31, v31
    v_cos_f32 v32, v28
    v_sin_f32 v28, v28
    v_cos_f32 v33, v29
    v_sin_f32 v29, v29
    v_cos_f32 v34, v30
    v_sin_f32 v30, v30
    v_cos_f32 v35, v31
    v_sin_f32 v31, v31
    v_mul_f32 v32, v24, v32
    v_mul_f32 v28, v24, v28
    v_mul_f32 v33, v25, v33
    v_mul_f32 v29, v25, v29
    v_mul_f32 v34, v26, v34
    v_mul_f32 v30, v26, v30
    v_mul_f32 v35, v27, v35
    v_mul_f32 v31, v27, v31
    v_cvt_pk_bf16_f32 v68, v32, v28
    v_cvt_pk_bf16_f32 v69, v33, v29
    v_cvt_pk_bf16_f32 v70, v34, v30
    v_cvt_pk_bf16_f32 v71, v35, v31
    v_lshlrev_b32 v24, 16, v68
    v_and_b32 v72, 0xffff0000, v68
    v_lshlrev_b32 v25, 16, v69
    v_and_b32 v73, 0xffff0000, v69
    v_lshlrev_b32 v26, 16, v70
    v_and_b32 v74, 0xffff0000, v70
    v_lshlrev_b32 v27, 16, v71
    v_and_b32 v75, 0xffff0000, v71
    v_sub_f32 v32, v32, v24
    v_sub_f32 v28, v28, v72
    v_sub_f32 v33, v33, v25
    v_sub_f32 v29, v29, v73
    v_sub_f32 v34, v34, v26
    v_sub_f32 v30, v30, v74
    v_sub_f32 v35, v35, v27
    v_sub_f32 v31, v31, v75
    v_cvt_pk_bf16_f32 v72, v32, v28
    v_cvt_pk_bf16_f32 v73, v33, v29
    v_cvt_pk_bf16_f32 v74, v34, v30
    v_cvt_pk_bf16_f32 v75, v35, v31
    v_mfma_f32_16x16x32_bf16 v[52:55], v[68:71], v[60:63], v[52:55]
    v_mfma_f32_16x16x32_bf16 v[52:55], v[68:71], v[64:67], v[52:55]
    v_mfma_f32_16x16x32_bf16 v[52:55], v[72:75], v[60:63], v[52:55]
    v_mul_f32 v24, v8, v43
    v_mul_f32 v28, v9, v43
    v_mul_f32 v25, v12, v43
    v_mul_f32 v29, v13, v43
    v_mul_f32 v26, v16, v43
    v_mul_f32 v30, v17, v43
    v_mul_f32 v27, v20, v43
    v_mul_f32 v31, v21, v43
    v_exp_f32 v24, v24
    v_fract_f32 v28, v28
    v_exp_f32 v25, v25
    v_fract_f32 v29, v29
    v_exp_f32 v26, v26
    v_fract_f32 v30, v30
    v_exp_f32 v27, v27
    v_fract_f32 v31, v31
    v_cos_f32 v32, v28
    v_sin_f32 v28, v28
    v_cos_f32 v33, v29
    v_sin_f32 v29, v29
    v_cos_f32 v34, v30
    v_sin_f32 v30, v30
    v_cos_f32 v35, v31
    v_sin_f32 v31, v31
    v_mul_f32 v32, v24, v32
    v_mul_f32 v28, v24, v28
    v_mul_f32 v33, v25, v33
    v_mul_f32 v29, v25, v29
    v_mul_f32 v34, v26, v34
    v_mul_f32 v30, v26, v30
    v_mul_f32 v35, v27, v35
    v_mul_f32 v31, v27, v31
    v_cvt_pk_bf16_f32 v68, v32, v28
    v_cvt_pk_bf16_f32 v69, v33, v29
    v_cvt_pk_bf16_f32 v70, v34, v30
    v_cvt_pk_bf16_f32 v71, v35, v31
    v_lshlrev_b32 v24, 16, v68
    v_and_b32 v72, 0xffff0000, v68
    v_lshlrev_b32 v25, 16, v69
    v_and_b32 v73, 0xffff0000, v69
    v_lshlrev_b32 v26, 16, v70
    v_and_b32 v74, 0xffff0000, v70
    v_lshlrev_b32 v27, 16, v71
    v_and_b32 v75, 0xffff0000, v71
    v_sub_f32 v32, v32, v24
    v_sub_f32 v28, v28, v72
    v_sub_f32 v33, v33, v25
    v_sub_f32 v29, v29, v73
    v_sub_f32 v34, v34, v26
    v_sub_f32 v30, v30, v74
    v_sub_f32 v35, v35, v27
    v_sub_f32 v31, v31, v75
    v_cvt_pk_bf16_f32 v72, v32, v28
    v_cvt_pk_bf16_f32 v73, v33, v29
    v_cvt_pk_bf16_f32 v74, v34, v30
    v_cvt_pk_bf16_f32 v75, v35, v31
    v_mfma_f32_16x16x32_bf16 v[56:59], v[68:71], v[60:63], v[56:59]
    v_mfma_f32_16x16x32_bf16 v[56:59], v[68:71], v[64:67], v[56:59]
    v_mfma_f32_16x16x32_bf16 v[56:59], v[72:75], v[60:63], v[56:59]
    s_add_u32 s4, s4, 1
    s_cmp_lt_u32 s4, 2
    s_cbranch_scc1 L_pp_loop
L_pp_ldn:

    v_mul_u32_u24 v5, 3072, v4
    v_add_u32 v5, 37888, v5
    v_lshrrev_b32 v6, 1, v3
    v_lshlrev_b32 v6, 7, v6
    v_and_b32 v7, 1, v3
    v_lshl_add_u32 v6, v7, 2, v6
    v_lshl_add_u32 v6, v2, 3, v6
    v_lshl_add_u32 v30, v6, 2, v5
    v_lshlrev_b32 v6, 6, v3
    v_lshl_add_u32 v7, v2, 2, v6
    v_add_u32 v7, 256, v7
    v_lshl_add_u32 v8, v2, 1, v6
    v_add_u32 v8, 256, v8
    v_cmp_gt_u32 vcc, 2, v3
    v_mov_b32 v9, 32
    s_nop 0
    v_cndmask_b32 v7, v8, v7, vcc
    v_cndmask_b32 v9, v9, 2, vcc
    v_lshl_add_u32 v31, v7, 2, v5
    v_add_u32 v7, v7, v9
    v_lshl_add_u32 v32, v7, 2, v5
    v_add_u32 v6, v6, v2
    v_add_u32 v6, 512, v6
    v_lshl_add_u32 v33, v6, 2, v5
    ds_write_b32 v30, v48
    ds_write_b32 v30, v49 offset:4
    ds_write_b32 v30, v50 offset:8
    ds_write_b32 v30, v51 offset:12
    ds_write_b32 v31, v52
    ds_write_b32 v31, v53 offset:4
    ds_write_b32 v32, v54
    ds_write_b32 v32, v55 offset:4
    ds_write_b32 v33, v56
    ds_write_b32 v33, v57 offset:64
    ds_write_b32 v33, v58 offset:128
    ds_write_b32 v33, v59 offset:192
    s_waitcnt vmcnt(0)
    s_cmp_lg_u32 s50, 3
    s_cbranch_scc1 L_pp_nocs
    v_mov_b32 v48, 0
    v_mov_b32 v49, 0
    v_lshlrev_b32 v50, 16, v128
    v_and_b32 v51, 0xffff0000, v128
    v_add_f32 v48, v48, v50
    v_add_f32 v49, v49, v51
    v_lshlrev_b32 v50, 16, v129
    v_and_b32 v51, 0xffff0000, v129
    v_add_f32 v48, v48, v50
    v_add_f32 v49, v49, v51
    v_lshlrev_b32 v50, 16, v130
    v_and_b32 v51, 0xffff0000, v130
    v_add_f32 v48, v48, v50
    v_add_f32 v49, v49, v51
    v_lshlrev_b32 v50, 16, v131
    v_and_b32 v51, 0xffff0000, v131
    v_add_f32 v48, v48, v50
    v_add_f32 v49, v49, v51
    v_lshlrev_b32 v50, 16, v132
    v_and_b32 v51, 0xffff0000, v132
    v_add_f32 v48, v48, v50
    v_add_f32 v49, v49, v51
    v_lshlrev_b32 v50, 16, v133
    v_and_b32 v51, 0xffff0000, v133
    v_add_f32 v48, v48, v50
    v_add_f32 v49, v49, v51
    v_lshlrev_b32 v50, 16, v134
    v_and_b32 v51, 0xffff0000, v134
    v_add_f32 v48, v48, v50
    v_add_f32 v49, v49, v51
    v_lshlrev_b32 v50, 16, v135
    v_and_b32 v51, 0xffff0000, v135
    v_add_f32 v48, v48, v50
    v_add_f32 v49, v49, v51
    v_lshlrev_b32 v50, 16, v136
    v_and_b32 v51, 0xffff0000, v136
    v_add_f32 v48, v48, v50
    v_add_f32 v49, v49, v51
    v_lshlrev_b32 v50, 16, v137
    v_and_b32 v51, 0xffff0000, v137
    v_add_f32 v48, v48, v50
    v_add_f32 v49, v49, v51
    v_lshlrev_b32 v50, 16, v138
    v_and_b32 v51, 0xffff0000, v138
    v_add_f32 v48, v48, v50
    v_add_f32 v49, v49, v51
    v_lshlrev_b32 v50, 16, v139
    v_and_b32 v51, 0xffff0000, v139
    v_add_f32 v48, v48, v50
    v_add_f32 v49, v49, v51
    v_lshlrev_b32 v50, 16, v140
    v_and_b32 v51, 0xffff0000, v140
    v_add_f32 v48, v48, v50
    v_add_f32 v49, v49, v51
    v_lshlrev_b32 v50, 16, v141
    v_and_b32 v51, 0xffff0000, v141
    v_add_f32 v48, v48, v50
    v_add_f32 v49, v49, v51
    v_lshlrev_b32 v50, 16, v142
    v_and_b32 v51, 0xffff0000, v142
    v_add_f32 v48, v48, v50
    v_add_f32 v49, v49, v51
    v_lshlrev_b32 v50, 16, v143
    v_and_b32 v51, 0xffff0000, v143
    v_add_f32 v48, v48, v50
    v_add_f32 v49, v49, v51
    v_lshlrev_b32 v50, 3, v0
    v_add_u32 v50, 84224, v50
    ds_write_b64 v50, v[48:49]
L_pp_nocs:
    v_lshrrev_b32 v4, 8, v0
    v_and_b32 v2, 255, v0
    v_mul_u32_u24 v6, 12288, v4
    v_add_u32 v6, 37888, v6
    v_lshlrev_b32 v13, 2, v2
    v_cmp_gt_u32 vcc, 816, v13
    v_mov_b32 v14, 943
    v_mov_b32 v15, 513
    v_mov_b32 v16, 775
    v_mov_b32 v17, 385
    v_cndmask_b32 v14, v14, v16, vcc
    v_cndmask_b32 v15, v15, v17, vcc
    s_movk_i32 s5, 616
    v_cmp_gt_u32 s[6:7], s5, v13
    s_movk_i32 s33, 384
    s_movk_i32 s34, 514
    s_movk_i32 s35, 256
    s_movk_i32 s36, 127
    v_add_u32 v20, 0, v13
    v_sub_u32 v21, 575, v20
    v_bfe_u32 v22, v21, 1, 1
    v_add_u32 v22, v22, v21
    v_lshrrev_b32 v22, 1, v22
    v_add_u32 v22, 128, v22
    v_min_u32 v22, s33, v22
    v_cmp_ge_u32 vcc, s35, v21
    v_sub_u32 v23, v14, v20
    v_cmp_ge_u32 s[8:9], s34, v21
    v_cndmask_b32 v22, v22, v21, vcc
    v_cmp_ge_u32 s[10:11], s36, v23
    v_add_u32 v23, v23, v15
    v_cndmask_b32 v22, v23, v22, s[6:7]
    s_and_b64 s[8:9], s[8:9], s[6:7]
    s_andn2_b64 s[10:11], s[10:11], s[6:7]
    s_or_b64 s[40:41], s[8:9], s[10:11]
    v_min_u32 v22, 767, v22
    v_lshl_add_u32 v36, v22, 2, v6
    v_add_u32 v20, 1, v13
    v_sub_u32 v21, 575, v20
    v_bfe_u32 v22, v21, 1, 1
    v_add_u32 v22, v22, v21
    v_lshrrev_b32 v22, 1, v22
    v_add_u32 v22, 128, v22
    v_min_u32 v22, s33, v22
    v_cmp_ge_u32 vcc, s35, v21
    v_sub_u32 v23, v14, v20
    v_cmp_ge_u32 s[8:9], s34, v21
    v_cndmask_b32 v22, v22, v21, vcc
    v_cmp_ge_u32 s[10:11], s36, v23
    v_add_u32 v23, v23, v15
    v_cndmask_b32 v22, v23, v22, s[6:7]
    s_and_b64 s[8:9], s[8:9], s[6:7]
    s_andn2_b64 s[10:11], s[10:11], s[6:7]
    s_or_b64 s[42:43], s[8:9], s[10:11]
    v_min_u32 v22, 767, v22
    v_lshl_add_u32 v37, v22, 2, v6
    v_add_u32 v20, 2, v13
    v_sub_u32 v21, 575, v20
    v_bfe_u32 v22, v21, 1, 1
    v_add_u32 v22, v22, v21
    v_lshrrev_b32 v22, 1, v22
    v_add_u32 v22, 128, v22
    v_min_u32 v22, s33, v22
    v_cmp_ge_u32 vcc, s35, v21
    v_sub_u32 v23, v14, v20
    v_cmp_ge_u32 s[8:9], s34, v21
    v_cndmask_b32 v22, v22, v21, vcc
    v_cmp_ge_u32 s[10:11], s36, v23
    v_add_u32 v23, v23, v15
    v_cndmask_b32 v22, v23, v22, s[6:7]
    s_and_b64 s[8:9], s[8:9], s[6:7]
    s_andn2_b64 s[10:11], s[10:11], s[6:7]
    s_or_b64 s[44:45], s[8:9], s[10:11]
    v_min_u32 v22, 767, v22
    v_lshl_add_u32 v38, v22, 2, v6
    v_add_u32 v20, 3, v13
    v_sub_u32 v21, 575, v20
    v_bfe_u32 v22, v21, 1, 1
    v_add_u32 v22, v22, v21
    v_lshrrev_b32 v22, 1, v22
    v_add_u32 v22, 128, v22
    v_min_u32 v22, s33, v22
    v_cmp_ge_u32 vcc, s35, v21
    v_sub_u32 v23, v14, v20
    v_cmp_ge_u32 s[8:9], s34, v21
    v_cndmask_b32 v22, v22, v21, vcc
    v_cmp_ge_u32 s[10:11], s36, v23
    v_add_u32 v23, v23, v15
    v_cndmask_b32 v22, v23, v22, s[6:7]
    s_and_b64 s[8:9], s[8:9], s[6:7]
    s_andn2_b64 s[10:11], s[10:11], s[6:7]
    s_or_b64 s[46:47], s[8:9], s[10:11]
    v_min_u32 v22, 767, v22
    v_lshl_add_u32 v39, v22, 2, v6
    s_waitcnt lgkmcnt(0)
    s_barrier
    ds_read_b32 v48, v36 offset:0
    ds_read_b32 v49, v36 offset:3072
    ds_read_b32 v50, v36 offset:6144
    ds_read_b32 v51, v36 offset:9216
    ds_read_b32 v52, v37 offset:0
    ds_read_b32 v53, v37 offset:3072
    ds_read_b32 v54, v37 offset:6144
    ds_read_b32 v55, v37 offset:9216
    s_waitcnt lgkmcnt(4)
    ds_read_b32 v56, v38 offset:0
    ds_read_b32 v57, v38 offset:3072
    ds_read_b32 v58, v38 offset:6144
    ds_read_b32 v59, v38 offset:9216
    ds_read_b32 v60, v39 offset:0
    ds_read_b32 v61, v39 offset:3072
    ds_read_b32 v62, v39 offset:6144
    ds_read_b32 v63, v39 offset:9216
    s_cmp_lg_u32 s70, 0
    s_cbranch_scc1 L_pp_noarr
    v_mov_b32 v200, 0
    global_load_dword v204, v200, s[100:101] sc1
    s_cmp_lg_u32 s50, 1
    s_cbranch_scc1 L_pp_noarr
    s_mov_b32 s12, 0
L_pp_rdy:
    global_load_dword v201, v200, s[100:101] sc1
    s_add_u32 s12, s12, 1
    s_waitcnt vmcnt(0)
    v_readfirstlane_b32 s13, v201
    s_cmp_gt_u32 s12, 0x400000
    s_cbranch_scc1 L_pp_rdyd
    s_cmp_eq_u32 s13, 0
    s_cbranch_scc1 L_pp_rdy
L_pp_rdyd:
    v_mov_b32 v201, 1
    s_and_b32 s12, s2, 3
    s_lshl_b32 s10, s12, 7
    s_add_u32 s10, s10, 8609792
    v_mov_b32 v202, s10
    s_mov_b64 exec, 1
    global_atomic_add v203, v202, v201, s[80:81] sc0 sc1
    s_mov_b64 exec, -1
L_pp_noarr:
    s_cmp_lg_u32 s50, 3
    s_cbranch_scc1 L_pp_nocs2
    s_cmp_lg_u32 s70, 1
    s_cbranch_scc1 L_pp_nocs2
    v_lshlrev_b32 v7, 3, v1
    v_add_u32 v8, 84224, v7
    ds_read_b64 v[100:101], v8 offset:0
    ds_read_b64 v[102:103], v8 offset:512
    ds_read_b64 v[104:105], v8 offset:1024
    ds_read_b64 v[106:107], v8 offset:1536
    ds_read_b64 v[108:109], v8 offset:2048
    ds_read_b64 v[110:111], v8 offset:2560
    ds_read_b64 v[112:113], v8 offset:3072
    ds_read_b64 v[114:115], v8 offset:3584
    s_waitcnt lgkmcnt(0)
    v_add_f32 v100, v100, v102
    v_add_f32 v101, v101, v103
    v_add_f32 v100, v100, v104
    v_add_f32 v101, v101, v105
    v_add_f32 v100, v100, v106
    v_add_f32 v101, v101, v107
    v_add_f32 v100, v100, v108
    v_add_f32 v101, v101, v109
    v_add_f32 v100, v100, v110
    v_add_f32 v101, v101, v111
    v_add_f32 v100, v100, v112
    v_add_f32 v101, v101, v113
    v_add_f32 v100, v100, v114
    v_add_f32 v101, v101, v115
    v_mov_b32 v102, v100
    v_mov_b32 v103, v101
    s_nop 0
    v_permlane32_swap_b32 v100, v102
    v_permlane32_swap_b32 v101, v103
    v_add_f32 v100, v100, v102
    v_add_f32 v101, v101, v103
    v_mov_b32 v102, v100
    v_mov_b32 v103, v101
    s_nop 0
    v_permlane16_swap_b32 v100, v102
    v_permlane16_swap_b32 v101, v103
    v_add_f32 v100, v100, v102
    v_add_f32 v101, v101, v103
    s_lshr_b32 s10, s51, 1
    s_lshl_b32 s10, s10, 7
    s_and_b32 s11, s51, 1
    s_lshl_b32 s11, s11, 13
    s_add_u32 s10, s10, s11
    s_add_u32 s10, s10, 8519680
    s_mov_b64 exec, 0xffff
    buffer_store_dwordx2 v[100:101], v7, s[24:27], s10 offen sc1
    s_mov_b64 exec, -1
L_pp_nocs2:
    s_waitcnt lgkmcnt(0)
    v_add_f32 v48, v48, v49
    v_add_f32 v50, v50, v51
    v_add_f32 v52, v52, v53
    v_add_f32 v54, v54, v55
    v_add_f32 v56, v56, v57
    v_add_f32 v58, v58, v59
    v_add_f32 v60, v60, v61
    v_add_f32 v62, v62, v63
    v_add_f32 v24, v48, v50
    v_add_f32 v25, v52, v54
    v_add_f32 v26, v56, v58
    v_add_f32 v27, v60, v62
    v_cndmask_b32 v24, 0, v24, s[40:41]
    v_cndmask_b32 v25, 0, v25, s[42:43]
    v_cndmask_b32 v26, 0, v26, s[44:45]
    v_cndmask_b32 v27, 0, v27, s[46:47]
    v_max3_f32 v7, abs(v24), abs(v25), abs(v26)
    v_max_f32 v7, abs(v27), v7
    s_nop 1
    v_max_f32 v7, v7, v7 quad_perm:[1,0,3,2]
    s_nop 1
    v_max_f32 v7, v7, v7 quad_perm:[2,3,0,1]
    s_nop 1
    v_max_f32 v7, v7, v7 row_half_mirror
    s_nop 1
    v_max_f32 v7, v7, v7 row_mirror
    v_lshrrev_b32 v8, 4, v0
    v_lshlrev_b32 v8, 2, v8
    v_add_u32 v8, 62464, v8
    ds_write_b32 v8, v7
    v_lshlrev_b32 v28, 6, v4
    v_add_u32 v28, 62464, v28
    v_lshlrev_b32 v29, 11, v4
    v_lshl_add_u32 v29, v2, 3, v29
    v_add_u32 v29, 62592, v29
    v_lshlrev_b32 v30, 3, v4
    v_add_u32 v30, 66688, v30
    s_movk_i32 s33, 162
    v_cmp_eq_u32 s[6:7], s33, v2
    s_waitcnt lgkmcnt(0)
    s_barrier
    ds_read_b128 v[8:11], v28
    ds_read_b128 v[12:15], v28 offset:16
    ds_read_b128 v[16:19], v28 offset:32
    ds_read_b128 v[20:23], v28 offset:48
    s_waitcnt lgkmcnt(0)
    v_max3_f32 v8, v8, v9, v10
    v_max3_f32 v11, v11, v12, v13
    v_max3_f32 v14, v14, v15, v16
    v_max3_f32 v17, v17, v18, v19
    v_max3_f32 v20, v20, v21, v22
    v_max3_f32 v8, v8, v11, v14
    v_max3_f32 v17, v17, v20, v23
    v_max_f32 v10, v8, v17
    v_lshrrev_b32 v10, 23, v10
    v_max_u32 v10, 40, v10
    v_min_u32 v10, 250, v10
    v_sub_u32 v11, 268, v10
    v_lshlrev_b32 v11, 23, v11
    v_subrev_u32 v12, 22, v10
    v_subrev_u32 v12, s38, v12
    v_max_i32 v12, 1, v12
    v_min_i32 v12, 0xfe, v12
    v_lshlrev_b32 v12, 23, v12
    v_mul_f32 v24, v24, v11
    v_mul_f32 v25, v25, v11
    v_mul_f32 v26, v26, v11
    v_mul_f32 v27, v27, v11
    v_cvt_pk_f16_f32 v32, v24, v25
    v_cvt_pk_f16_f32 v33, v26, v27
    v_readfirstlane_b32 s72, v12
    ds_write_b64 v29, v[32:33]
    s_mov_b64 exec, s[6:7]
    ds_write_b32 v30, v24
    s_mov_b64 exec, -1
    v_and_b32 v5, 127, v2
    v_lshlrev_b32 v5, 4, v5
    v_lshl_add_u32 v6, v4, 11, v5
    v_add_u32 v6, 62592, v6
    v_mul_u32_u24 v7, 16896, v4
    v_add_u32 v5, v5, v7
    s_lshl_b32 s17, s49, 16
    s_and_b32 s16, s49, 0xffff0000
    s_cmp_lt_u32 s70, 4
    s_cselect_b32 s16, s17, s16
    v_mov_b32 v7, 0x3b800000
    v_mul_f32 v7, s16, v7
    s_waitcnt lgkmcnt(0)
    s_barrier
    v_readfirstlane_b32 s71, v7
    ds_read_b32 v8, v30
    ds_read_b128 v[64:67], v6
    ds_read_b128 v[68:71], v6 offset:16
    s_waitcnt lgkmcnt(0)
    v_readfirstlane_b32 s73, v8
    s_bitcmp1_b32 s70, 1
    s_cbranch_scc1 L_pp_notab
    v_alignbit_b32 v72, v65, v64, 16
    v_alignbit_b32 v73, v66, v65, 16
    v_alignbit_b32 v74, v67, v66, 16
    v_alignbit_b32 v75, v68, v67, 16
    v_alignbit_b32 v76, v69, v68, 16
    v_alignbit_b32 v77, v70, v69, 16
    v_alignbit_b32 v78, v71, v70, 16
    v_alignbit_b32 v80, v66, v65, 16
    v_alignbit_b32 v81, v67, v66, 16
    v_alignbit_b32 v82, v68, v67, 16
    v_alignbit_b32 v83, v69, v68, 16
    v_alignbit_b32 v84, v70, v69, 16
    v_alignbit_b32 v85, v71, v70, 16
    v_mov_b32 v88, v65
    v_mov_b32 v89, v66
    v_mov_b32 v90, v67
    v_mov_b32 v91, v68
    v_mov_b32 v92, v69
    v_mov_b32 v93, v70
    ds_write_b128 v5, v[64:67] offset:0
    ds_write_b128 v5, v[72:75] offset:2112
    ds_write_b128 v5, v[88:91] offset:4224
    ds_write_b128 v5, v[80:83] offset:6336
    ds_write_b128 v5, v[66:69] offset:8448
    ds_write_b128 v5, v[74:77] offset:10560
    ds_write_b128 v5, v[90:93] offset:12672
    ds_write_b128 v5, v[82:85] offset:14784
L_pp_notab:
    s_waitcnt lgkmcnt(0)

    s_and_b32 s10, s2, 31
    s_lshl_b32 s10, s10, 7
    s_add_u32 s10, s10, 8611840
    v_and_b32 v200, 63, v0
    v_lshlrev_b32 v206, 2, v200
    v_add_u32 v206, s10, v206
    s_cmp_lg_u32 s70, 0
    s_cbranch_scc1 L_pp_nolast
    v_mov_b32 v205, 0
    s_mov_b32 s12, 0
L_pp_rdy2:
    s_waitcnt vmcnt(0)
    v_readfirstlane_b32 s13, v204
    s_add_u32 s12, s12, 1
    s_cmp_lg_u32 s13, 0
    s_cbranch_scc1 L_pp_rdy2d
    s_cmp_gt_u32 s12, 0x400000
    s_cbranch_scc1 L_pp_rdy2d
    global_load_dword v204, v205, s[100:101] sc1
    s_branch L_pp_rdy2
L_pp_rdy2d:
    s_cmp_lg_u32 s50, 1
    s_cbranch_scc1 L_pp_nolast
    s_and_b32 s12, s2, 3
    s_lshl_b32 s12, s12, 2
    s_add_u32 s12, s12, 8611840
    v_lshlrev_b32 v202, 7, v200
    v_add_u32 v202, s12, v202
    s_waitcnt vmcnt(0)
    v_readfirstlane_b32 s10, v203
    s_cmp_lg_u32 s10, 15
    s_cbranch_scc1 L_pp_nolast
    s_mov_b64 exec, 0xffffffff
    global_store_dword v202, v201, s[80:81] sc1
    s_mov_b64 exec, -1
L_pp_nolast:
    v_and_b32 v1, 63, v0
    v_and_b32 v2, 15, v0
    v_lshrrev_b32 v3, 4, v1
    v_lshrrev_b32 v4, 6, v0
    s_lshr_b32 s4, s2, 4
    s_cmp_ge_u32 s2, 240
    s_cbranch_scc1 L_pp_adone
    v_bfe_u32 v5, v0, 1, 1
    v_mul_u32_u24 v5, 8704, v5
    v_bfe_u32 v6, v0, 2, 2
    v_lshl_add_u32 v5, v6, 2, v5
    v_and_b32 v6, 1, v0
    v_lshl_add_u32 v5, v6, 1, v5
    v_mul_u32_u24 v6, 1088, v3
    v_add_u32 v5, v5, v6
    v_lshl_add_u32 v5, v4, 4, v5
    v_add_u32 v5, 66816, v5
    v_lshlrev_b32 v7, 4, v1
    s_and_b32 s5, s2, 15
    s_mov_b32 s6, s70
    ds_read_u16 v100, v5 offset:0
    ds_read_u16 v101, v5 offset:272
    ds_read_u16 v102, v5 offset:544
    ds_read_u16 v103, v5 offset:816
    ds_read_u16 v104, v5 offset:4352
    ds_read_u16 v105, v5 offset:4624
    ds_read_u16 v106, v5 offset:4896
    ds_read_u16 v107, v5 offset:5168
    s_mul_i32 s7, s6, 11
    s_lshr_b32 s7, s7, 5
    s_mul_i32 s12, s7, 3
    s_sub_u32 s12, s6, s12
    s_lshl_b32 s13, s4, 2
    s_add_u32 s13, s13, s7
    s_lshl_b32 s13, s13, 4
    s_add_u32 s13, s13, s5
    s_mul_i32 s13, s13, 3
    s_add_u32 s13, s13, s12
    s_lshl_b32 s13, s13, 10
    s_add_u32 s13, s13, 12582912
    s_waitcnt lgkmcnt(0)
    v_lshl_or_b32 v116, v101, 16, v100
    v_lshl_or_b32 v117, v103, 16, v102
    v_lshl_or_b32 v118, v105, 16, v104
    v_lshl_or_b32 v119, v107, 16, v106
    buffer_store_dwordx4 v[116:119], v7, s[24:27], s13 offen sc1
    s_cmp_ge_u32 s70, 4
    s_cbranch_scc1 L_pp_adone
    s_add_u32 s6, s6, 8
    ds_read_u16 v100, v5 offset:128
    ds_read_u16 v101, v5 offset:400
    ds_read_u16 v102, v5 offset:672
    ds_read_u16 v103, v5 offset:944
    ds_read_u16 v104, v5 offset:4480
    ds_read_u16 v105, v5 offset:4752
    ds_read_u16 v106, v5 offset:5024
    ds_read_u16 v107, v5 offset:5296
    s_mul_i32 s7, s6, 11
    s_lshr_b32 s7, s7, 5
    s_mul_i32 s12, s7, 3
    s_sub_u32 s12, s6, s12
    s_lshl_b32 s13, s4, 2
    s_add_u32 s13, s13, s7
    s_lshl_b32 s13, s13, 4
    s_add_u32 s13, s13, s5
    s_mul_i32 s13, s13, 3
    s_add_u32 s13, s13, s12
    s_lshl_b32 s13, s13, 10
    s_add_u32 s13, s13, 12582912
    s_waitcnt lgkmcnt(0)
    v_lshl_or_b32 v120, v101, 16, v100
    v_lshl_or_b32 v121, v103, 16, v102
    v_lshl_or_b32 v122, v105, 16, v104
    v_lshl_or_b32 v123, v107, 16, v106
    buffer_store_dwordx4 v[120:123], v7, s[24:27], s13 offen sc1
L_pp_adone:
    s_cmp_lg_u32 s50, 2
    s_cbranch_scc1 L_pp_wdd
    v_lshlrev_b32 v5, 1, v2
    v_mul_u32_u24 v6, 1056, v3
    v_add_u32 v5, v5, v6
    v_lshl_add_u32 v5, v4, 6, v5
    v_add_u32 v5, 84224, v5
    v_lshlrev_b32 v7, 4, v1
    s_lshr_b32 s7, s70, 1
    s_and_b32 s12, s51, 1
    s_lshl_b32 s12, s12, 2
    s_add_u32 s7, s7, s12
    s_mul_i32 s7, s7, 43
    s_lshr_b32 s12, s51, 1
    s_add_u32 s7, s7, s12
    s_lshl_b32 s7, s7, 2
    s_and_b32 s12, s70, 1
    s_lshl_b32 s12, s12, 1
    s_add_u32 s7, s7, s12
    s_lshl_b32 s7, s7, 10
    s_add_u32 s7, s7, 16777216
    ds_read_u16 v100, v5 offset:0
    ds_read_u16 v101, v5 offset:528
    ds_read_u16 v102, v5 offset:4224
    ds_read_u16 v103, v5 offset:4752
    ds_read_u16 v104, v5 offset:8448
    ds_read_u16 v105, v5 offset:8976
    ds_read_u16 v106, v5 offset:12672
    ds_read_u16 v107, v5 offset:13200
    s_waitcnt lgkmcnt(0)
    v_lshl_or_b32 v108, v101, 16, v100
    v_lshl_or_b32 v109, v103, 16, v102
    v_lshl_or_b32 v110, v105, 16, v104
    v_lshl_or_b32 v111, v107, 16, v106
    buffer_store_dwordx4 v[108:111], v7, s[24:27], s7 offen offset:0 sc1
    ds_read_u16 v100, v5 offset:32
    ds_read_u16 v101, v5 offset:560
    ds_read_u16 v102, v5 offset:4256
    ds_read_u16 v103, v5 offset:4784
    ds_read_u16 v104, v5 offset:8480
    ds_read_u16 v105, v5 offset:9008
    ds_read_u16 v106, v5 offset:12704
    ds_read_u16 v107, v5 offset:13232
    s_waitcnt lgkmcnt(0)
    v_lshl_or_b32 v112, v101, 16, v100
    v_lshl_or_b32 v113, v103, 16, v102
    v_lshl_or_b32 v114, v105, 16, v104
    v_lshl_or_b32 v115, v107, 16, v106
    buffer_store_dwordx4 v[112:115], v7, s[24:27], s7 offen offset:1024 sc1
L_pp_wdd:
    s_cmp_lg_u32 s70, 0
    s_cbranch_scc1 L_b0_join
    s_mov_b64 exec, 15
    s_mov_b32 s12, 0
    s_movk_i32 s13, 1
L_b0_poll:
    global_load_dword v5, v206, s[80:81] sc1
    s_add_u32 s12, s12, 1
    s_waitcnt vmcnt(0)
    v_cmp_gt_u32 vcc, s13, v5
    s_cmp_gt_u32 s12, 0x400000
    s_cbranch_scc1 L_b0_to
    s_cbranch_vccnz L_b0_poll
L_b0_to:
    s_mov_b64 exec, -1
L_b0_join:
    s_barrier
L_mega_layer:
    s_waitcnt vmcnt(0)
    v_and_b32 v2, 255, v0
    s_lshr_b32 s5, s70, 2
    s_and_b32 s4, s70, 3
    s_lshl_b32 s3, s2, 1
    s_add_u32 s3, s3, s5
    s_lshl_b32 s6, s3, 12
    s_mul_i32 s7, s5, 55040
    s_add_u32 s7, s7, 33792
    s_mul_i32 s17, s5, 16896
    v_lshlrev_b32 v3, 4, v2
    v_lshlrev_b32 v4, 5, v2
    s_add_u32 s8, s6, s65
    s_add_u32 s9, s66, 8192
    buffer_load_dwordx4 v[16:19], v4, s[24:27], s66 offen sc0 sc1
    buffer_load_dwordx4 v[20:23], v4, s[24:27], s66 offen offset:16 sc0 sc1
    buffer_load_dwordx4 v[24:27], v4, s[24:27], s9 offen sc0 sc1
    buffer_load_dwordx4 v[28:31], v4, s[24:27], s9 offen offset:16 sc0 sc1
    buffer_load_dwordx4 v[8:11], v3, s[24:27], s8 offen sc1
    v_mov_b32 v32, 0
    v_mov_b32 v33, 0
    v_mov_b32 v34, 0
    v_mov_b32 v35, 0
    v_add_u32 v5, s7, v3
    v_cmp_gt_u32 vcc, 90, v2
    s_and_saveexec_b64 s[18:19], vcc
    ds_write_b128 v5, v[32:35] offset:0
    s_mov_b64 exec, s[18:19]
    v_bfe_u32 v5, v2, 4, 3
    v_mul_u32_u24 v5, 1040, v5
    v_and_b32 v6, 15, v2
    v_lshl_add_u32 v5, v6, 4, v5
    v_add_u32 v5, s7, v5
    ds_write_b128 v5, v[32:35] offset:16768
    s_mov_b32 s28, 0x3b000000
    s_mov_b32 s29, 0x3727c5ac
    s_mov_b32 s30, 0x43800000
    v_lshrrev_b32 v5, 4, v2
    v_mul_u32_u24 v5, 288, v5
    v_lshl_add_u32 v5, v6, 4, v5
    v_add_u32 v7, s7, v5
    s_waitcnt vmcnt(1)
    v_mul_f32 v16, s28, v16
    v_mul_f32 v24, s28, v24
    v_mul_f32 v17, s28, v17
    v_mul_f32 v25, s28, v25
    v_mul_f32 v18, s28, v18
    v_mul_f32 v26, s28, v26
    v_mul_f32 v19, s28, v19
    v_mul_f32 v27, s28, v27
    v_mul_f32 v20, s28, v20
    v_mul_f32 v28, s28, v28
    v_mul_f32 v21, s28, v21
    v_mul_f32 v29, s28, v29
    v_mul_f32 v22, s28, v22
    v_mul_f32 v30, s28, v30
    v_mul_f32 v23, s28, v23
    v_mul_f32 v31, s28, v31
    v_fma_f32 v24, -v16, v16, v24
    v_fma_f32 v25, -v17, v17, v25
    v_fma_f32 v26, -v18, v18, v26
    v_fma_f32 v27, -v19, v19, v27
    v_fma_f32 v28, -v20, v20, v28
    v_fma_f32 v29, -v21, v21, v29
    v_fma_f32 v30, -v22, v22, v30
    v_fma_f32 v31, -v23, v23, v31
    v_max_f32 v24, 0, v24
    v_max_f32 v25, 0, v25
    v_max_f32 v26, 0, v26
    v_max_f32 v27, 0, v27
    v_max_f32 v28, 0, v28
    v_max_f32 v29, 0, v29
    v_max_f32 v30, 0, v30
    v_max_f32 v31, 0, v31
    v_add_f32 v24, s29, v24
    v_add_f32 v25, s29, v25
    v_add_f32 v26, s29, v26
    v_add_f32 v27, s29, v27
    v_add_f32 v28, s29, v28
    v_add_f32 v29, s29, v29
    v_add_f32 v30, s29, v30
    v_add_f32 v31, s29, v31
    v_rsq_f32 v24, v24
    v_rsq_f32 v25, v25
    v_rsq_f32 v26, v26
    v_rsq_f32 v27, v27
    v_rsq_f32 v28, v28
    v_rsq_f32 v29, v29
    v_rsq_f32 v30, v30
    v_rsq_f32 v31, v31
    s_waitcnt vmcnt(0)
    v_lshlrev_b32 v48, 16, v8
    v_and_b32 v49, 0xffff0000, v8
    v_lshlrev_b32 v50, 16, v9
    v_and_b32 v51, 0xffff0000, v9
    v_lshlrev_b32 v52, 16, v10
    v_and_b32 v53, 0xffff0000, v10
    v_lshlrev_b32 v54, 16, v11
    v_and_b32 v55, 0xffff0000, v11
    v_mul_f32 v24, s30, v24
    v_mul_f32 v25, s30, v25
    v_mul_f32 v26, s30, v26
    v_mul_f32 v27, s30, v27
    v_mul_f32 v28, s30, v28
    v_mul_f32 v29, s30, v29
    v_mul_f32 v30, s30, v30
    v_mul_f32 v31, s30, v31
    v_sub_f32 v48, v48, v16
    v_sub_f32 v49, v49, v17
    v_sub_f32 v50, v50, v18
    v_sub_f32 v51, v51, v19
    v_sub_f32 v52, v52, v20
    v_sub_f32 v53, v53, v21
    v_sub_f32 v54, v54, v22
    v_sub_f32 v55, v55, v23
    v_mul_f32 v48, v48, v24
    v_mul_f32 v49, v49, v25
    v_mul_f32 v50, v50, v26
    v_mul_f32 v51, v51, v27
    v_mul_f32 v52, v52, v28
    v_mul_f32 v53, v53, v29
    v_mul_f32 v54, v54, v30
    v_mul_f32 v55, v55, v31
    v_cvt_pk_f16_f32 v12, v48, v49
    v_cvt_pk_f16_f32 v13, v50, v51
    v_cvt_pk_f16_f32 v14, v52, v53
    v_cvt_pk_f16_f32 v15, v54, v55
    ds_write_b128 v7, v[12:15] offset:1440
    s_waitcnt lgkmcnt(0)
    s_barrier
    s_cmp_ge_u32 s4, 3
    s_cbranch_scc1 L_mc_nobox
    v_subrev_u32 v5, 3, v2
    v_ashrrev_i32 v6, 4, v5
    v_mul_i32_i24 v6, 288, v6
    v_and_b32 v5, 15, v5
    v_lshl_add_u32 v5, v5, 4, v6
    v_add_u32 v5, s7, v5
    ds_read_b128 v[16:19], v5 offset:1440
    v_subrev_u32 v5, 2, v2
    v_ashrrev_i32 v6, 4, v5
    v_mul_i32_i24 v6, 288, v6
    v_and_b32 v5, 15, v5
    v_lshl_add_u32 v5, v5, 4, v6
    v_add_u32 v5, s7, v5
    ds_read_b128 v[20:23], v5 offset:1440
    v_subrev_u32 v5, 1, v2
    v_ashrrev_i32 v6, 4, v5
    v_mul_i32_i24 v6, 288, v6
    v_and_b32 v5, 15, v5
    v_lshl_add_u32 v5, v5, 4, v6
    v_add_u32 v5, s7, v5
    ds_read_b128 v[24:27], v5 offset:1440
    s_waitcnt lgkmcnt(0)
    v_cvt_f32_f16 v44, v18
    v_cvt_f32_f16 v45, v18 src0_sel:WORD_1
    v_cvt_f32_f16 v46, v19
    v_cvt_f32_f16 v47, v19 src0_sel:WORD_1
    v_cvt_f32_f16 v48, v20
    v_cvt_f32_f16 v49, v20 src0_sel:WORD_1
    v_cvt_f32_f16 v50, v21
    v_cvt_f32_f16 v51, v21 src0_sel:WORD_1
    v_cvt_f32_f16 v52, v22
    v_cvt_f32_f16 v53, v22 src0_sel:WORD_1
    v_cvt_f32_f16 v54, v23
    v_cvt_f32_f16 v55, v23 src0_sel:WORD_1
    v_cvt_f32_f16 v56, v24
    v_cvt_f32_f16 v57, v24 src0_sel:WORD_1
    v_cvt_f32_f16 v58, v25
    v_cvt_f32_f16 v59, v25 src0_sel:WORD_1
    v_cvt_f32_f16 v60, v26
    v_cvt_f32_f16 v61, v26 src0_sel:WORD_1
    v_cvt_f32_f16 v62, v27
    v_cvt_f32_f16 v63, v27 src0_sel:WORD_1
    v_cvt_f32_f16 v64, v12
    v_cvt_f32_f16 v65, v12 src0_sel:WORD_1
    v_cvt_f32_f16 v66, v13
    v_cvt_f32_f16 v67, v13 src0_sel:WORD_1
    v_cvt_f32_f16 v68, v14
    v_add_f32 v45, v45, v44
    v_add_f32 v46, v46, v45
    v_add_f32 v47, v47, v46
    v_add_f32 v48, v48, v47
    v_add_f32 v49, v49, v48
    v_add_f32 v50, v50, v49
    v_add_f32 v51, v51, v50
    v_add_f32 v52, v52, v51
    v_add_f32 v53, v53, v52
    v_add_f32 v54, v54, v53
    v_add_f32 v55, v55, v54
    v_add_f32 v56, v56, v55
    v_add_f32 v57, v57, v56
    v_add_f32 v58, v58, v57
    v_add_f32 v59, v59, v58
    v_add_f32 v60, v60, v59
    v_add_f32 v61, v61, v60
    v_add_f32 v62, v62, v61
    v_add_f32 v63, v63, v62
    v_add_f32 v64, v64, v63
    v_add_f32 v65, v65, v64
    v_add_f32 v66, v66, v65
    v_add_f32 v67, v67, v66
    v_add_f32 v68, v68, v67
    v_sub_f32 v72, v58, v53
    v_sub_f32 v73, v61, v58
    v_sub_f32 v74, v59, v54
    v_sub_f32 v75, v62, v59
    v_sub_f32 v76, v60, v55
    v_sub_f32 v77, v63, v60
    v_sub_f32 v78, v61, v56
    v_sub_f32 v79, v64, v61
    v_sub_f32 v80, v62, v57
    v_sub_f32 v81, v65, v62
    v_sub_f32 v82, v63, v58
    v_sub_f32 v83, v66, v63
    v_sub_f32 v84, v64, v59
    v_sub_f32 v85, v67, v64
    v_sub_f32 v86, v65, v60
    v_sub_f32 v87, v68, v65
    v_cvt_pk_f16_f32 v16, v72, v73
    v_cvt_pk_f16_f32 v17, v74, v75
    v_cvt_pk_f16_f32 v18, v76, v77
    v_cvt_pk_f16_f32 v19, v78, v79
    v_cvt_pk_f16_f32 v20, v80, v81
    v_cvt_pk_f16_f32 v21, v82, v83
    v_cvt_pk_f16_f32 v22, v84, v85
    v_cvt_pk_f16_f32 v23, v86, v87
    v_lshlrev_b32 v5, 2, v2
    v_add_u32 v5, s7, v5
    ds_write_b32 v5, v16 offset:17024
    ds_write_b32 v5, v17 offset:18064
    ds_write_b32 v5, v18 offset:19104
    ds_write_b32 v5, v19 offset:20144
    ds_write_b32 v5, v20 offset:21184
    ds_write_b32 v5, v21 offset:22224
    ds_write_b32 v5, v22 offset:23264
    ds_write_b32 v5, v23 offset:24304
    s_cmp_ge_u32 s4, 2
    s_cbranch_scc1 L_mc_nobox
    v_mov_b32 v72, v52
    v_sub_f32 v73, v59, v52
    v_sub_f32 v74, v53, v44
    v_sub_f32 v75, v60, v53
    v_sub_f32 v76, v54, v45
    v_sub_f32 v77, v61, v54
    v_sub_f32 v78, v55, v46
    v_sub_f32 v79, v62, v55
    v_sub_f32 v80, v56, v47
    v_sub_f32 v81, v63, v56
    v_sub_f32 v82, v57, v48
    v_sub_f32 v83, v64, v57
    v_sub_f32 v84, v58, v49
    v_sub_f32 v85, v65, v58
    v_sub_f32 v86, v59, v50
    v_sub_f32 v87, v66, v59
    v_cvt_pk_f16_f32 v96, v72, v73
    v_cvt_pk_f16_f32 v97, v74, v75
    v_cvt_pk_f16_f32 v98, v76, v77
    v_cvt_pk_f16_f32 v99, v78, v79
    v_cvt_pk_f16_f32 v100, v80, v81
    v_cvt_pk_f16_f32 v101, v82, v83
    v_cvt_pk_f16_f32 v102, v84, v85
    v_cvt_pk_f16_f32 v103, v86, v87
    v_and_b32 v5, 1, v2
    v_mul_u32_u24 v5, 2304, v5
    v_lshrrev_b32 v6, 1, v2
    v_lshl_add_u32 v5, v6, 2, v5
    v_add_u32 v5, s7, v5
    ds_write_b32 v5, v96 offset:25088
    ds_write_b32 v5, v97 offset:25376
    ds_write_b32 v5, v98 offset:25664
    ds_write_b32 v5, v99 offset:25952
    ds_write_b32 v5, v100 offset:26240
    ds_write_b32 v5, v101 offset:26528
    ds_write_b32 v5, v102 offset:26816
    ds_write_b32 v5, v103 offset:27104
L_mc_nobox:
    v_and_b32 v1, 63, v0
    v_and_b32 v3, 15, v1
    v_lshrrev_b32 v4, 4, v1
    s_cmp_eq_u32 s4, 3
    s_cbranch_scc1 L_mc_far
    v_and_b32 v5, 7, v3
    v_sub_u32 v5, 7, v5
    v_mul_u32_u24 v5, 2112, v5
    v_lshrrev_b32 v6, 3, v3
    v_sub_u32 v6, v4, v6
    v_lshl_add_u32 v5, v6, 4, v5
    s_mul_i32 s8, s4, 384
    s_sub_u32 s8, s17, s8
    s_add_u32 s8, s8, 784
    v_add_u32 v5, s8, v5
    v_mul_u32_u24 v6, 288, v3
    v_lshl_add_u32 v6, v4, 4, v6
    s_mul_i32 s9, s4, 6
    s_sub_u32 s9, 3, s9
    s_waitcnt lgkmcnt(0)
    s_barrier
    ds_read_b128 v[84:87], v5 offset:352
    s_ashr_i32 s10, s9, 2
    s_mul_i32 s10, s10, 288
    s_and_b32 s11, s9, 3
    s_lshl_b32 s11, s11, 6
    s_add_u32 s10, s10, s11
    s_add_u32 s10, s10, s7
    s_sub_u32 s9, s9, 1
    v_add_u32 v7, s10, v6
    ds_read_b128 v[48:51], v7 offset:1440
    ds_read_b128 v[88:91], v5 offset:320
    s_ashr_i32 s10, s9, 2
    s_mul_i32 s10, s10, 288
    s_and_b32 s11, s9, 3
    s_lshl_b32 s11, s11, 6
    s_add_u32 s10, s10, s11
    s_add_u32 s10, s10, s7
    s_sub_u32 s9, s9, 1
    v_add_u32 v7, s10, v6
    ds_read_b128 v[52:55], v7 offset:1440
    ds_read_b128 v[92:95], v5 offset:288
    s_ashr_i32 s10, s9, 2
    s_mul_i32 s10, s10, 288
    s_and_b32 s11, s9, 3
    s_lshl_b32 s11, s11, 6
    s_add_u32 s10, s10, s11
    s_add_u32 s10, s10, s7
    s_sub_u32 s9, s9, 1
    v_add_u32 v7, s10, v6
    ds_read_b128 v[56:59], v7 offset:1440
    ds_read_b128 v[96:99], v5 offset:256
    s_ashr_i32 s10, s9, 2
    s_mul_i32 s10, s10, 288
    s_and_b32 s11, s9, 3
    s_lshl_b32 s11, s11, 6
    s_add_u32 s10, s10, s11
    s_add_u32 s10, s10, s7
    s_sub_u32 s9, s9, 1
    v_add_u32 v7, s10, v6
    ds_read_b128 v[60:63], v7 offset:1440
    ds_read_b128 v[100:103], v5 offset:224
    s_ashr_i32 s10, s9, 2
    s_mul_i32 s10, s10, 288
    s_and_b32 s11, s9, 3
    s_lshl_b32 s11, s11, 6
    s_add_u32 s10, s10, s11
    s_add_u32 s10, s10, s7
    s_sub_u32 s9, s9, 1
    v_add_u32 v7, s10, v6
    ds_read_b128 v[64:67], v7 offset:1440
    ds_read_b128 v[104:107], v5 offset:192
    s_ashr_i32 s10, s9, 2
    s_mul_i32 s10, s10, 288
    s_and_b32 s11, s9, 3
    s_lshl_b32 s11, s11, 6
    s_add_u32 s10, s10, s11
    s_add_u32 s10, s10, s7
    s_sub_u32 s9, s9, 1
    v_add_u32 v7, s10, v6
    ds_read_b128 v[68:71], v7 offset:1440
    ds_read_b128 v[108:111], v5 offset:160
    s_ashr_i32 s10, s9, 2
    s_mul_i32 s10, s10, 288
    s_and_b32 s11, s9, 3
    s_lshl_b32 s11, s11, 6
    s_add_u32 s10, s10, s11
    s_add_u32 s10, s10, s7
    s_sub_u32 s9, s9, 1
    v_add_u32 v7, s10, v6
    ds_read_b128 v[72:75], v7 offset:1440
    ds_read_b128 v[112:115], v5 offset:128
    s_ashr_i32 s10, s9, 2
    s_mul_i32 s10, s10, 288
    s_and_b32 s11, s9, 3
    s_lshl_b32 s11, s11, 6
    s_add_u32 s10, s10, s11
    s_add_u32 s10, s10, s7
    s_sub_u32 s9, s9, 1
    v_add_u32 v7, s10, v6
    ds_read_b128 v[76:79], v7 offset:1440
    ds_read_b128 v[116:119], v5 offset:96
    s_ashr_i32 s10, s9, 2
    s_mul_i32 s10, s10, 288
    s_and_b32 s11, s9, 3
    s_lshl_b32 s11, s11, 6
    s_add_u32 s10, s10, s11
    s_add_u32 s10, s10, s7
    s_sub_u32 s9, s9, 1
    v_add_u32 v7, s10, v6
    ds_read_b128 v[80:83], v7 offset:1440
    ds_read_b128 v[120:123], v5 offset:64
    ds_read_b128 v[124:127], v5 offset:32
    ds_read_b128 v[128:131], v5 offset:0
    s_waitcnt lgkmcnt(15)
    v_mfma_f32_16x16x32_f16 v[40:43], v[84:87], v[48:51], 0
    s_waitcnt lgkmcnt(15)
    v_mfma_f32_16x16x32_f16 v[44:47], v[88:91], v[48:51], 0
    s_waitcnt lgkmcnt(15)
    v_mfma_f32_16x16x32_f16 v[32:35], v[84:87], v[52:55], 0
    s_waitcnt lgkmcnt(15)
    v_mfma_f32_16x16x32_f16 v[36:39], v[88:91], v[52:55], 0
    s_waitcnt lgkmcnt(15)
    v_mfma_f32_16x16x32_f16 v[40:43], v[92:95], v[52:55], v[40:43]
    s_waitcnt lgkmcnt(14)
    v_mfma_f32_16x16x32_f16 v[44:47], v[96:99], v[52:55], v[44:47]
    v_mfma_f32_16x16x32_f16 v[24:27], v[84:87], v[56:59], 0
    v_mfma_f32_16x16x32_f16 v[28:31], v[88:91], v[56:59], 0
    v_mfma_f32_16x16x32_f16 v[32:35], v[92:95], v[56:59], v[32:35]
    v_mfma_f32_16x16x32_f16 v[36:39], v[96:99], v[56:59], v[36:39]
    s_waitcnt lgkmcnt(12)
    v_mfma_f32_16x16x32_f16 v[40:43], v[100:103], v[56:59], v[40:43]
    s_waitcnt lgkmcnt(10)
    v_mfma_f32_16x16x32_f16 v[44:47], v[104:107], v[56:59], v[44:47]
    v_mfma_f32_16x16x32_f16 v[16:19], v[84:87], v[60:63], 0
    v_mfma_f32_16x16x32_f16 v[20:23], v[88:91], v[60:63], 0
    v_mfma_f32_16x16x32_f16 v[24:27], v[92:95], v[60:63], v[24:27]
    v_mfma_f32_16x16x32_f16 v[28:31], v[96:99], v[60:63], v[28:31]
    v_mfma_f32_16x16x32_f16 v[32:35], v[100:103], v[60:63], v[32:35]
    v_mfma_f32_16x16x32_f16 v[36:39], v[104:107], v[60:63], v[36:39]
    s_waitcnt lgkmcnt(8)
    v_mfma_f32_16x16x32_f16 v[40:43], v[108:111], v[60:63], v[40:43]
    s_waitcnt lgkmcnt(6)
    v_mfma_f32_16x16x32_f16 v[44:47], v[112:115], v[60:63], v[44:47]
    v_mfma_f32_16x16x32_f16 v[16:19], v[92:95], v[64:67], v[16:19]
    v_mfma_f32_16x16x32_f16 v[20:23], v[96:99], v[64:67], v[20:23]
    v_mfma_f32_16x16x32_f16 v[24:27], v[100:103], v[64:67], v[24:27]
    v_mfma_f32_16x16x32_f16 v[28:31], v[104:107], v[64:67], v[28:31]
    v_mfma_f32_16x16x32_f16 v[32:35], v[108:111], v[64:67], v[32:35]
    v_mfma_f32_16x16x32_f16 v[36:39], v[112:115], v[64:67], v[36:39]
    s_waitcnt lgkmcnt(4)
    v_mfma_f32_16x16x32_f16 v[40:43], v[116:119], v[64:67], v[40:43]
    s_waitcnt lgkmcnt(2)
    v_mfma_f32_16x16x32_f16 v[44:47], v[120:123], v[64:67], v[44:47]
    v_mfma_f32_16x16x32_f16 v[16:19], v[100:103], v[68:71], v[16:19]
    v_mfma_f32_16x16x32_f16 v[20:23], v[104:107], v[68:71], v[20:23]
    v_mfma_f32_16x16x32_f16 v[24:27], v[108:111], v[68:71], v[24:27]
    v_mfma_f32_16x16x32_f16 v[28:31], v[112:115], v[68:71], v[28:31]
    v_mfma_f32_16x16x32_f16 v[32:35], v[116:119], v[68:71], v[32:35]
    v_mfma_f32_16x16x32_f16 v[36:39], v[120:123], v[68:71], v[36:39]
    s_waitcnt lgkmcnt(1)
    v_mfma_f32_16x16x32_f16 v[40:43], v[124:127], v[68:71], v[40:43]
    s_waitcnt lgkmcnt(0)
    v_mfma_f32_16x16x32_f16 v[44:47], v[128:131], v[68:71], v[44:47]
    v_mfma_f32_16x16x32_f16 v[16:19], v[108:111], v[72:75], v[16:19]
    v_mfma_f32_16x16x32_f16 v[20:23], v[112:115], v[72:75], v[20:23]
    v_mfma_f32_16x16x32_f16 v[24:27], v[116:119], v[72:75], v[24:27]
    v_mfma_f32_16x16x32_f16 v[28:31], v[120:123], v[72:75], v[28:31]
    v_mfma_f32_16x16x32_f16 v[32:35], v[124:127], v[72:75], v[32:35]
    v_mfma_f32_16x16x32_f16 v[36:39], v[128:131], v[72:75], v[36:39]
    v_mfma_f32_16x16x32_f16 v[16:19], v[116:119], v[76:79], v[16:19]
    v_mfma_f32_16x16x32_f16 v[20:23], v[120:123], v[76:79], v[20:23]
    v_mfma_f32_16x16x32_f16 v[24:27], v[124:127], v[76:79], v[24:27]
    v_mfma_f32_16x16x32_f16 v[28:31], v[128:131], v[76:79], v[28:31]
    v_mfma_f32_16x16x32_f16 v[16:19], v[124:127], v[80:83], v[16:19]
    v_mfma_f32_16x16x32_f16 v[20:23], v[128:131], v[80:83], v[20:23]
    v_mul_u32_u24 v5, 528, v3
    v_lshl_add_u32 v5, v4, 4, v5
    s_mul_i32 s8, s4, 8448
    s_add_u32 s8, s8, s7
    v_add_u32 v5, s8, v5
    s_nop 1
    ds_write_b128 v5, v[16:19] offset:29696
    ds_write_b128 v5, v[20:23] offset:29760
    ds_write_b128 v5, v[24:27] offset:29824
    ds_write_b128 v5, v[28:31] offset:29888
    ds_write_b128 v5, v[32:35] offset:29952
    ds_write_b128 v5, v[36:39] offset:30016
    ds_write_b128 v5, v[40:43] offset:30080
    ds_write_b128 v5, v[44:47] offset:30144
    s_branch L_mc_epi
L_mc_far:
    v_and_b32 v5, 3, v3
    v_lshlrev_b32 v5, 1, v5
    v_sub_u32 v5, 6, v5
    v_mul_u32_u24 v5, 2112, v5
    v_lshrrev_b32 v6, 2, v3
    v_sub_u32 v6, v4, v6
    v_lshl_add_u32 v5, v6, 4, v5
    s_add_u32 s8, s17, 1232
    v_add_u32 v5, s8, v5
    v_and_b32 v6, 7, v3
    v_mul_u32_u24 v6, 1040, v6
    v_lshrrev_b32 v7, 3, v3
    v_mul_u32_u24 v7, 384, v7
    v_add_u32 v6, v6, v7
    v_lshl_add_u32 v6, v4, 4, v6
    v_add_u32 v6, s7, v6
    v_mul_u32_u24 v7, 288, v3
    v_lshl_add_u32 v7, v4, 4, v7
    v_add_u32 v7, s7, v7
    ds_read_b128 v[64:67], v5 offset:48
    ds_read_b128 v[68:71], v5 offset:112
    ds_read_b128 v[72:75], v5 offset:176
    ds_read_b128 v[76:79], v5 offset:240
    ds_read_b128 v[80:83], v5 offset:304
    ds_read_b128 v[124:127], v5 offset:640
    ds_read_b128 v[128:131], v5 offset:576
    ds_read_b128 v[132:135], v5 offset:512
    ds_read_b128 v[136:139], v5 offset:448
    s_barrier
    ds_read_b128 v[84:87], v6 offset:16768
    ds_read_b128 v[88:91], v6 offset:16832
    ds_read_b128 v[92:95], v6 offset:16896
    ds_read_b128 v[96:99], v6 offset:16960
    ds_read_b128 v[100:103], v6 offset:17024
    ds_read_b128 v[104:107], v6 offset:17088
    ds_read_b128 v[108:111], v6 offset:17152
    ds_read_b128 v[112:115], v6 offset:17216
    ds_read_b128 v[116:119], v6 offset:17280
    ds_read_b128 v[120:123], v6 offset:17344
    ds_read_b128 v[140:143], v7 offset:25088
    ds_read_b128 v[144:147], v7 offset:25152
    ds_read_b128 v[148:151], v7 offset:25216
    ds_read_b128 v[152:155], v7 offset:25280
    s_waitcnt lgkmcnt(4)
    v_mfma_f32_16x16x32_f16 v[16:19], v[64:67], v[84:87], 0
    v_mfma_f32_16x16x32_f16 v[16:19], v[68:71], v[88:91], v[16:19]
    v_mfma_f32_16x16x32_f16 v[16:19], v[72:75], v[92:95], v[16:19]
    v_mfma_f32_16x16x32_f16 v[16:19], v[76:79], v[96:99], v[16:19]
    v_mfma_f32_16x16x32_f16 v[16:19], v[80:83], v[100:103], v[16:19]
    v_mfma_f32_16x16x32_f16 v[20:23], v[64:67], v[88:91], 0
    v_mfma_f32_16x16x32_f16 v[20:23], v[68:71], v[92:95], v[20:23]
    v_mfma_f32_16x16x32_f16 v[20:23], v[72:75], v[96:99], v[20:23]
    v_mfma_f32_16x16x32_f16 v[20:23], v[76:79], v[100:103], v[20:23]
    v_mfma_f32_16x16x32_f16 v[20:23], v[80:83], v[104:107], v[20:23]
    v_mfma_f32_16x16x32_f16 v[24:27], v[64:67], v[92:95], 0
    v_mfma_f32_16x16x32_f16 v[24:27], v[68:71], v[96:99], v[24:27]
    v_mfma_f32_16x16x32_f16 v[24:27], v[72:75], v[100:103], v[24:27]
    v_mfma_f32_16x16x32_f16 v[24:27], v[76:79], v[104:107], v[24:27]
    v_mfma_f32_16x16x32_f16 v[24:27], v[80:83], v[108:111], v[24:27]
    v_mfma_f32_16x16x32_f16 v[28:31], v[64:67], v[96:99], 0
    v_mfma_f32_16x16x32_f16 v[28:31], v[68:71], v[100:103], v[28:31]
    v_mfma_f32_16x16x32_f16 v[28:31], v[72:75], v[104:107], v[28:31]
    v_mfma_f32_16x16x32_f16 v[28:31], v[76:79], v[108:111], v[28:31]
    v_mfma_f32_16x16x32_f16 v[28:31], v[80:83], v[112:115], v[28:31]
    v_mfma_f32_16x16x32_f16 v[32:35], v[64:67], v[100:103], 0
    v_mfma_f32_16x16x32_f16 v[32:35], v[68:71], v[104:107], v[32:35]
    v_mfma_f32_16x16x32_f16 v[32:35], v[72:75], v[108:111], v[32:35]
    v_mfma_f32_16x16x32_f16 v[32:35], v[76:79], v[112:115], v[32:35]
    v_mfma_f32_16x16x32_f16 v[32:35], v[80:83], v[116:119], v[32:35]
    v_mfma_f32_16x16x32_f16 v[36:39], v[64:67], v[104:107], 0
    v_mfma_f32_16x16x32_f16 v[36:39], v[68:71], v[108:111], v[36:39]
    v_mfma_f32_16x16x32_f16 v[36:39], v[72:75], v[112:115], v[36:39]
    v_mfma_f32_16x16x32_f16 v[36:39], v[76:79], v[116:119], v[36:39]
    v_mfma_f32_16x16x32_f16 v[36:39], v[80:83], v[120:123], v[36:39]
    s_waitcnt lgkmcnt(0)
    v_mfma_f32_16x16x32_f16 v[40:43], v[124:127], v[140:143], 0
    v_mfma_f32_16x16x32_f16 v[44:47], v[128:131], v[140:143], 0
    v_mfma_f32_16x16x32_f16 v[44:47], v[124:127], v[144:147], v[44:47]
    v_mfma_f32_16x16x32_f16 v[48:51], v[132:135], v[140:143], 0
    v_mfma_f32_16x16x32_f16 v[48:51], v[128:131], v[144:147], v[48:51]
    v_mfma_f32_16x16x32_f16 v[48:51], v[124:127], v[148:151], v[48:51]
    v_mfma_f32_16x16x32_f16 v[52:55], v[136:139], v[140:143], 0
    v_mfma_f32_16x16x32_f16 v[52:55], v[132:135], v[144:147], v[52:55]
    v_mfma_f32_16x16x32_f16 v[52:55], v[128:131], v[148:151], v[52:55]
    v_mfma_f32_16x16x32_f16 v[52:55], v[124:127], v[152:155], v[52:55]
    v_and_b32 v5, 7, v3
    v_mul_u32_u24 v5, 784, v5
    v_lshrrev_b32 v6, 3, v3
    v_mul_u32_u24 v6, 384, v6
    v_add_u32 v5, v5, v6
    v_lshl_add_u32 v5, v4, 4, v5
    v_add_u32 v5, s7, v5
    v_mul_u32_u24 v6, 272, v3
    v_lshl_add_u32 v6, v4, 4, v6
    v_add_u32 v6, s7, v6
    ds_write_b128 v5, v[16:19] offset:6144
    ds_write_b128 v5, v[20:23] offset:6208
    ds_write_b128 v5, v[24:27] offset:6272
    ds_write_b128 v5, v[28:31] offset:6336
    ds_write_b128 v5, v[32:35] offset:6400
    ds_write_b128 v5, v[36:39] offset:6464
    ds_write_b128 v6, v[40:43] offset:12416
    ds_write_b128 v6, v[44:47] offset:12480
    ds_write_b128 v6, v[48:51] offset:12544
    ds_write_b128 v6, v[52:55] offset:12608
L_mc_epi:
    v_lshrrev_b32 v5, 4, v2
    v_mul_u32_u24 v5, 528, v5
    v_and_b32 v6, 15, v2
    v_lshl_add_u32 v5, v6, 5, v5
    v_add_u32 v5, s7, v5
    s_waitcnt lgkmcnt(0)
    s_barrier
    ds_read_b128 v[16:19], v5 offset:29696
    ds_read_b128 v[20:23], v5 offset:29712
    ds_read_b128 v[24:27], v5 offset:38144
    ds_read_b128 v[28:31], v5 offset:38160
    ds_read_b128 v[32:35], v5 offset:46592
    ds_read_b128 v[36:39], v5 offset:46608
    s_cmp_eq_u32 s4, 0
    s_cbranch_scc1 L_mc_e0
    v_lshlrev_b32 v5, 2, v2
    v_add_u32 v5, s7, v5
    ds_read_b32 v40, v5 offset:5888
    ds_read_b32 v41, v5 offset:6672
    ds_read_b32 v42, v5 offset:7456
    ds_read_b32 v43, v5 offset:8240
    ds_read_b32 v44, v5 offset:9024
    ds_read_b32 v45, v5 offset:9808
    ds_read_b32 v46, v5 offset:10592
    ds_read_b32 v47, v5 offset:11376
    s_cmp_eq_u32 s4, 1
    s_cbranch_scc1 L_mc_e1
    v_and_b32 v5, 1, v2
    v_mul_u32_u24 v5, 2176, v5
    v_lshrrev_b32 v6, 1, v2
    v_lshl_add_u32 v5, v6, 2, v5
    v_add_u32 v5, s7, v5
    ds_read_b32 v48, v5 offset:12160
    ds_read_b32 v49, v5 offset:12432
    ds_read_b32 v50, v5 offset:12704
    ds_read_b32 v51, v5 offset:12976
    ds_read_b32 v52, v5 offset:13248
    ds_read_b32 v53, v5 offset:13520
    ds_read_b32 v54, v5 offset:13792
    ds_read_b32 v55, v5 offset:14064
    v_subrev_u32 v5, 129, v2
    v_ashrrev_i32 v6, 4, v5
    v_mul_i32_i24 v6, 288, v6
    v_and_b32 v5, 15, v5
    v_lshl_add_u32 v5, v5, 4, v6
    v_add_u32 v5, s7, v5
    ds_read_b128 v[56:59], v5 offset:1440
    v_subrev_u32 v5, 128, v2
    v_ashrrev_i32 v6, 4, v5
    v_mul_i32_i24 v6, 288, v6
    v_and_b32 v5, 15, v5
    v_lshl_add_u32 v5, v5, 4, v6
    v_add_u32 v5, s7, v5
    ds_read_b128 v[60:63], v5 offset:1440
    s_waitcnt lgkmcnt(0)
    v_cvt_f32_f16 v68, v58
    v_cvt_f32_f16 v69, v58 src0_sel:WORD_1
    v_cvt_f32_f16 v70, v59
    v_cvt_f32_f16 v71, v59 src0_sel:WORD_1
    v_cvt_f32_f16 v72, v60
    v_cvt_f32_f16 v73, v60 src0_sel:WORD_1
    v_cvt_f32_f16 v74, v61
    v_cvt_f32_f16 v75, v61 src0_sel:WORD_1
    v_cvt_f32_f16 v76, v62
    v_add_f32 v68, v68, v69
    v_add_f32 v69, v69, v70
    v_add_f32 v70, v70, v71
    v_add_f32 v71, v71, v72
    v_add_f32 v72, v72, v73
    v_add_f32 v73, v73, v74
    v_add_f32 v74, v74, v75
    v_add_f32 v75, v75, v76
    v_fma_f32 v48, v68, s73, v48
    v_fma_f32 v49, v69, s73, v49
    v_fma_f32 v50, v70, s73, v50
    v_fma_f32 v51, v71, s73, v51
    v_fma_f32 v52, v72, s73, v52
    v_fma_f32 v53, v73, s73, v53
    v_fma_f32 v54, v74, s73, v54
    v_fma_f32 v55, v75, s73, v55
    v_add_f32 v40, v40, v48
    v_add_f32 v41, v41, v49
    v_add_f32 v42, v42, v50
    v_add_f32 v43, v43, v51
    v_add_f32 v44, v44, v52
    v_add_f32 v45, v45, v53
    v_add_f32 v46, v46, v54
    v_add_f32 v47, v47, v55
L_mc_e1:
    s_waitcnt lgkmcnt(0)
    v_add_f32 v32, v32, v40
    v_add_f32 v33, v33, v41
    v_add_f32 v34, v34, v42
    v_add_f32 v35, v35, v43
    v_add_f32 v36, v36, v44
    v_add_f32 v37, v37, v45
    v_add_f32 v38, v38, v46
    v_add_f32 v39, v39, v47
L_mc_e0:
    s_waitcnt lgkmcnt(0)
    v_add_f32 v16, v16, v24
    v_add_f32 v17, v17, v25
    v_add_f32 v18, v18, v26
    v_add_f32 v19, v19, v27
    v_add_f32 v20, v20, v28
    v_add_f32 v21, v21, v29
    v_add_f32 v22, v22, v30
    v_add_f32 v23, v23, v31
    v_add_f32 v16, v16, v32
    v_add_f32 v17, v17, v33
    v_add_f32 v18, v18, v34
    v_add_f32 v19, v19, v35
    v_add_f32 v20, v20, v36
    v_add_f32 v21, v21, v37
    v_add_f32 v22, v22, v38
    v_add_f32 v23, v23, v39
    v_mov_b32 v40, s71
    v_lshlrev_b32 v24, 16, v8
    v_and_b32 v25, 0xffff0000, v8
    v_lshlrev_b32 v26, 16, v9
    v_and_b32 v27, 0xffff0000, v9
    v_lshlrev_b32 v28, 16, v10
    v_and_b32 v29, 0xffff0000, v10
    v_lshlrev_b32 v30, 16, v11
    v_and_b32 v31, 0xffff0000, v11
    v_fma_f32 v16, v16, s72, v24
    v_fma_f32 v17, v17, s72, v25
    v_fma_f32 v18, v18, s72, v26
    v_fma_f32 v19, v19, s72, v27
    v_fma_f32 v20, v20, s72, v28
    v_fma_f32 v21, v21, s72, v29
    v_fma_f32 v22, v22, s72, v30
    v_fma_f32 v23, v23, s72, v31
    v_fma_mix_f32 v16, v12, v40, v16 op_sel_hi:[1,0,0]
    v_fma_mix_f32 v17, v12, v40, v17 op_sel:[1,0,0] op_sel_hi:[1,0,0]
    v_fma_mix_f32 v18, v13, v40, v18 op_sel_hi:[1,0,0]
    v_fma_mix_f32 v19, v13, v40, v19 op_sel:[1,0,0] op_sel_hi:[1,0,0]
    v_fma_mix_f32 v20, v14, v40, v20 op_sel_hi:[1,0,0]
    v_fma_mix_f32 v21, v14, v40, v21 op_sel:[1,0,0] op_sel_hi:[1,0,0]
    v_fma_mix_f32 v22, v15, v40, v22 op_sel_hi:[1,0,0]
    v_fma_mix_f32 v23, v15, v40, v23 op_sel:[1,0,0] op_sel_hi:[1,0,0]
    v_cvt_pk_bf16_f32 v32, v16, v17
    v_cvt_pk_bf16_f32 v33, v18, v19
    v_cvt_pk_bf16_f32 v34, v20, v21
    v_cvt_pk_bf16_f32 v35, v22, v23
    v_lshlrev_b32 v3, 4, v2
    s_add_u32 s8, s6, s67
    buffer_store_dwordx4 v[32:35], v3, s[24:27], s8 offen sc1
    s_waitcnt vmcnt(0)
    s_barrier
    s_cmp_lg_u32 s70, 0
    s_cbranch_scc1 L_b1_nosig
    s_add_u32 s11, s69, 0
    v_and_b32 v1, 63, v0
    v_mov_b32 v2, 1
    s_and_b32 s12, s2, 15
    s_lshl_b32 s10, s12, 7
    s_add_u32 s10, s10, s11
    v_mov_b32 v3, s10
    s_mov_b64 exec, 1
    global_atomic_add v4, v3, v2, s[80:81] sc0 sc1
    s_mov_b64 exec, -1
    s_add_u32 s11, s11, 2048
    s_lshl_b32 s12, s12, 2
    s_add_u32 s12, s12, s11
    v_lshlrev_b32 v3, 7, v1
    v_add_u32 v3, s12, v3
    s_and_b32 s10, s2, 31
    s_lshl_b32 s10, s10, 7
    s_add_u32 s10, s10, s11
    v_lshlrev_b32 v7, 2, v1
    v_add_u32 v7, s10, v7
    s_waitcnt vmcnt(0)
    v_readfirstlane_b32 s10, v4
    s_cmp_lg_u32 s10, 15
    s_cbranch_scc1 L_b1_nolast
    s_mov_b64 exec, 0xffffffff
    global_store_dword v3, v2, s[80:81] sc1
    s_mov_b64 exec, -1
L_b1_nolast:
L_b1_nosig:
    s_cmp_eq_u32 s64, 0
    s_cbranch_scc1 L_gpe_skip
    s_cmp_lt_u32 s70, 4
    s_cbranch_scc1 L_gup_skipe
    s_and_b32 s5, s70, 3
    s_lshl_b32 s6, s75, 2
    s_add_u32 s6, s6, s5
    s_mul_i32 s6, s6, 49152
    s_add_u32 s6, s6, 12582912
    v_and_b32 v6, 63, v0
    v_lshlrev_b32 v6, 4, v6
    s_mul_i32 s7, s5, 0
    s_add_u32 s7, s7, 84992
    buffer_load_dwordx4 v[192:195], v6, s[24:27], s6 offen offset:0 sc1
    buffer_load_dwordx4 v[196:199], v6, s[24:27], s6 offen offset:1024 sc1
    buffer_load_dwordx4 v[200:203], v6, s[24:27], s6 offen offset:2048 sc1
    s_add_u32 s6, s6, 3072
    buffer_load_dwordx4 v[204:207], v6, s[24:27], s6 offen offset:0 sc1
    buffer_load_dwordx4 v[208:211], v6, s[24:27], s6 offen offset:1024 sc1
    buffer_load_dwordx4 v[212:215], v6, s[24:27], s6 offen offset:2048 sc1
    s_add_u32 s6, s6, 3072
    buffer_load_dwordx4 v[216:219], v6, s[24:27], s6 offen offset:0 sc1
    buffer_load_dwordx4 v[220:223], v6, s[24:27], s6 offen offset:1024 sc1
    buffer_load_dwordx4 v[224:227], v6, s[24:27], s6 offen offset:2048 sc1
    s_add_u32 s6, s6, 3072
    buffer_load_dwordx4 v[228:231], v6, s[24:27], s6 offen offset:0 sc1
    buffer_load_dwordx4 v[232:235], v6, s[24:27], s6 offen offset:1024 sc1
    buffer_load_dwordx4 v[236:239], v6, s[24:27], s6 offen offset:2048 sc1
    s_add_u32 s6, s6, 3072
L_gup_skipe:
L_gpe_skip:
    s_cmp_lg_u32 s70, 0
    s_cbranch_scc1 L_b1_join
    s_mov_b64 exec, 65535
    s_mov_b32 s12, 0
    s_movk_i32 s13, 1
L_b1_poll:
    global_load_dword v5, v7, s[80:81] sc1
    s_add_u32 s12, s12, 1
    s_waitcnt vmcnt(0)
    v_cmp_gt_u32 vcc, s13, v5
    s_cmp_gt_u32 s12, 0x400000
    s_cbranch_scc1 L_b1_to
    s_cbranch_vccnz L_b1_poll
L_b1_to:
    s_mov_b64 exec, -1
L_b1_join:
    s_barrier
    s_cmp_lg_u32 s64, 0
    s_cbranch_scc1 L_gpl_skip
    s_cmp_lt_u32 s70, 4
    s_cbranch_scc1 L_gup_skipl
    s_and_b32 s5, s70, 3
    s_lshl_b32 s6, s75, 2
    s_add_u32 s6, s6, s5
    s_mul_i32 s6, s6, 49152
    s_add_u32 s6, s6, 12582912
    v_and_b32 v6, 63, v0
    v_lshlrev_b32 v6, 4, v6
    s_mul_i32 s7, s5, 0
    s_add_u32 s7, s7, 84992
    buffer_load_dwordx4 v[192:195], v6, s[24:27], s6 offen offset:0 sc1
    buffer_load_dwordx4 v[196:199], v6, s[24:27], s6 offen offset:1024 sc1
    buffer_load_dwordx4 v[200:203], v6, s[24:27], s6 offen offset:2048 sc1
    s_add_u32 s6, s6, 3072
    buffer_load_dwordx4 v[204:207], v6, s[24:27], s6 offen offset:0 sc1
    buffer_load_dwordx4 v[208:211], v6, s[24:27], s6 offen offset:1024 sc1
    buffer_load_dwordx4 v[212:215], v6, s[24:27], s6 offen offset:2048 sc1
    s_add_u32 s6, s6, 3072
    buffer_load_dwordx4 v[216:219], v6, s[24:27], s6 offen offset:0 sc1
    buffer_load_dwordx4 v[220:223], v6, s[24:27], s6 offen offset:1024 sc1
    buffer_load_dwordx4 v[224:227], v6, s[24:27], s6 offen offset:2048 sc1
    s_add_u32 s6, s6, 3072
    buffer_load_dwordx4 v[228:231], v6, s[24:27], s6 offen offset:0 sc1
    buffer_load_dwordx4 v[232:235], v6, s[24:27], s6 offen offset:1024 sc1
    buffer_load_dwordx4 v[236:239], v6, s[24:27], s6 offen offset:2048 sc1
    s_add_u32 s6, s6, 3072
L_gup_skipl:
L_gpl_skip:
    s_cmp_ge_u32 s75, 15
    s_cbranch_scc1 L_mg_idle
    v_and_b32 v1, 63, v0
    v_lshlrev_b32 v2, 4, v1
    v_add_u32 v9, 33792, v2
    v_lshrrev_b32 v6, 4, v1
    v_lshlrev_b32 v6, 3, v6
    s_and_b32 s5, s70, 3
    s_mul_i32 s7, s5, 3
    s_mul_i32 s8, s75, 3
    s_lshl_b32 s9, s74, 1
    s_mul_i32 s9, s9, 43
    s_cmp_lt_u32 s70, 4
    s_cbranch_scc1 L_mg_helper
    s_mul_i32 s16, s5, 0
    s_add_u32 s16, s16, 51200
    v_add_u32 v8, s16, v9
    v_lshrrev_b32 v3, 4, v1
    v_bfe_u32 v4, v1, 2, 2
    v_lshl_add_u32 v3, v3, 2, v4
    v_mul_u32_u24 v3, 288, v3
    v_and_b32 v4, 3, v1
    v_lshl_add_u32 v3, v4, 3, v3
    v_add_u32 v3, 33792, v3
    s_barrier
    ds_read_b64_tr_b16 v[128:129], v3 offset:0
    ds_read_b64_tr_b16 v[130:131], v3 offset:4608
    ds_read_b64_tr_b16 v[132:133], v3 offset:32
    ds_read_b64_tr_b16 v[134:135], v3 offset:4640
    ds_read_b64_tr_b16 v[136:137], v3 offset:64
    ds_read_b64_tr_b16 v[138:139], v3 offset:4672
    ds_read_b64_tr_b16 v[140:141], v3 offset:96
    ds_read_b64_tr_b16 v[142:143], v3 offset:4704
    ds_read_b64_tr_b16 v[144:145], v3 offset:128
    ds_read_b64_tr_b16 v[146:147], v3 offset:4736
    ds_read_b64_tr_b16 v[148:149], v3 offset:160
    ds_read_b64_tr_b16 v[150:151], v3 offset:4768
    ds_read_b64_tr_b16 v[152:153], v3 offset:192
    ds_read_b64_tr_b16 v[154:155], v3 offset:4800
    ds_read_b64_tr_b16 v[156:157], v3 offset:224
    ds_read_b64_tr_b16 v[158:159], v3 offset:4832
    s_waitcnt vmcnt(9) lgkmcnt(0)
    v_mfma_f32_16x16x32_bf16 v[32:35], v[192:195], v[128:131], 0
    buffer_load_dwordx4 v[240:243], v2, s[24:27], s6 offen offset:0 sc1
    v_mfma_f32_16x16x32_bf16 v[64:67], v[196:199], v[128:131], 0
    buffer_load_dwordx4 v[244:247], v2, s[24:27], s6 offen offset:1024 sc1
    v_mfma_f32_16x16x32_bf16 v[96:99], v[200:203], v[128:131], 0
    buffer_load_dwordx4 v[248:251], v2, s[24:27], s6 offen offset:2048 sc1
    s_add_u32 s6, s6, 3072
    v_mfma_f32_16x16x32_bf16 v[36:39], v[192:195], v[132:135], 0
    ds_read_b64_tr_b16 v[160:161], v3 offset:9216
    v_mfma_f32_16x16x32_bf16 v[68:71], v[196:199], v[132:135], 0
    ds_read_b64_tr_b16 v[162:163], v3 offset:13824
    v_mfma_f32_16x16x32_bf16 v[100:103], v[200:203], v[132:135], 0
    ds_read_b64_tr_b16 v[164:165], v3 offset:9248
    v_mfma_f32_16x16x32_bf16 v[40:43], v[192:195], v[136:139], 0
    ds_read_b64_tr_b16 v[166:167], v3 offset:13856
    v_mfma_f32_16x16x32_bf16 v[72:75], v[196:199], v[136:139], 0
    ds_read_b64_tr_b16 v[168:169], v3 offset:9280
    v_mfma_f32_16x16x32_bf16 v[104:107], v[200:203], v[136:139], 0
    ds_read_b64_tr_b16 v[170:171], v3 offset:13888
    v_mfma_f32_16x16x32_bf16 v[44:47], v[192:195], v[140:143], 0
    ds_read_b64_tr_b16 v[172:173], v3 offset:9312
    v_mfma_f32_16x16x32_bf16 v[76:79], v[196:199], v[140:143], 0
    ds_read_b64_tr_b16 v[174:175], v3 offset:13920
    v_mfma_f32_16x16x32_bf16 v[108:111], v[200:203], v[140:143], 0
    ds_read_b64_tr_b16 v[176:177], v3 offset:9344
    v_mfma_f32_16x16x32_bf16 v[48:51], v[192:195], v[144:147], 0
    ds_read_b64_tr_b16 v[178:179], v3 offset:13952
    v_mfma_f32_16x16x32_bf16 v[80:83], v[196:199], v[144:147], 0
    ds_read_b64_tr_b16 v[180:181], v3 offset:9376
    v_mfma_f32_16x16x32_bf16 v[112:115], v[200:203], v[144:147], 0
    ds_read_b64_tr_b16 v[182:183], v3 offset:13984
    v_mfma_f32_16x16x32_bf16 v[52:55], v[192:195], v[148:151], 0
    ds_read_b64_tr_b16 v[184:185], v3 offset:9408
    v_mfma_f32_16x16x32_bf16 v[84:87], v[196:199], v[148:151], 0
    ds_read_b64_tr_b16 v[186:187], v3 offset:14016
    v_mfma_f32_16x16x32_bf16 v[116:119], v[200:203], v[148:151], 0
    ds_read_b64_tr_b16 v[188:189], v3 offset:9440
    v_mfma_f32_16x16x32_bf16 v[56:59], v[192:195], v[152:155], 0
    ds_read_b64_tr_b16 v[190:191], v3 offset:14048
    v_mfma_f32_16x16x32_bf16 v[88:91], v[196:199], v[152:155], 0
    v_mfma_f32_16x16x32_bf16 v[120:123], v[200:203], v[152:155], 0
    v_mfma_f32_16x16x32_bf16 v[60:63], v[192:195], v[156:159], 0
    v_mfma_f32_16x16x32_bf16 v[92:95], v[196:199], v[156:159], 0
    v_mfma_f32_16x16x32_bf16 v[124:127], v[200:203], v[156:159], 0
    s_waitcnt lgkmcnt(0)
    s_barrier
    s_waitcnt vmcnt(9) lgkmcnt(0)
    v_mfma_f32_16x16x32_bf16 v[32:35], v[204:207], v[160:163], v[32:35]
    buffer_load_dwordx4 v[192:195], v2, s[24:27], s6 offen offset:0 sc1
    v_mfma_f32_16x16x32_bf16 v[64:67], v[208:211], v[160:163], v[64:67]
    buffer_load_dwordx4 v[196:199], v2, s[24:27], s6 offen offset:1024 sc1
    v_mfma_f32_16x16x32_bf16 v[96:99], v[212:215], v[160:163], v[96:99]
    buffer_load_dwordx4 v[200:203], v2, s[24:27], s6 offen offset:2048 sc1
    s_add_u32 s6, s6, 3072
    v_mfma_f32_16x16x32_bf16 v[36:39], v[204:207], v[164:167], v[36:39]
    ds_read_b64_tr_b16 v[128:129], v3 offset:18432
    v_mfma_f32_16x16x32_bf16 v[68:71], v[208:211], v[164:167], v[68:71]
    ds_read_b64_tr_b16 v[130:131], v3 offset:23040
    v_mfma_f32_16x16x32_bf16 v[100:103], v[212:215], v[164:167], v[100:103]
    ds_read_b64_tr_b16 v[132:133], v3 offset:18464
    v_mfma_f32_16x16x32_bf16 v[40:43], v[204:207], v[168:171], v[40:43]
    ds_read_b64_tr_b16 v[134:135], v3 offset:23072
    v_mfma_f32_16x16x32_bf16 v[72:75], v[208:211], v[168:171], v[72:75]
    ds_read_b64_tr_b16 v[136:137], v3 offset:18496
    v_mfma_f32_16x16x32_bf16 v[104:107], v[212:215], v[168:171], v[104:107]
    ds_read_b64_tr_b16 v[138:139], v3 offset:23104
    v_mfma_f32_16x16x32_bf16 v[44:47], v[204:207], v[172:175], v[44:47]
    ds_read_b64_tr_b16 v[140:141], v3 offset:18528
    v_mfma_f32_16x16x32_bf16 v[76:79], v[208:211], v[172:175], v[76:79]
    ds_read_b64_tr_b16 v[142:143], v3 offset:23136
    v_mfma_f32_16x16x32_bf16 v[108:111], v[212:215], v[172:175], v[108:111]
    ds_read_b64_tr_b16 v[144:145], v3 offset:18560
    v_mfma_f32_16x16x32_bf16 v[48:51], v[204:207], v[176:179], v[48:51]
    ds_read_b64_tr_b16 v[146:147], v3 offset:23168
    v_mfma_f32_16x16x32_bf16 v[80:83], v[208:211], v[176:179], v[80:83]
    ds_read_b64_tr_b16 v[148:149], v3 offset:18592
    v_mfma_f32_16x16x32_bf16 v[112:115], v[212:215], v[176:179], v[112:115]
    ds_read_b64_tr_b16 v[150:151], v3 offset:23200
    v_mfma_f32_16x16x32_bf16 v[52:55], v[204:207], v[180:183], v[52:55]
    ds_read_b64_tr_b16 v[152:153], v3 offset:18624
    v_mfma_f32_16x16x32_bf16 v[84:87], v[208:211], v[180:183], v[84:87]
    ds_read_b64_tr_b16 v[154:155], v3 offset:23232
    v_mfma_f32_16x16x32_bf16 v[116:119], v[212:215], v[180:183], v[116:119]
    ds_read_b64_tr_b16 v[156:157], v3 offset:18656
    v_mfma_f32_16x16x32_bf16 v[56:59], v[204:207], v[184:187], v[56:59]
    ds_read_b64_tr_b16 v[158:159], v3 offset:23264
    v_mfma_f32_16x16x32_bf16 v[88:91], v[208:211], v[184:187], v[88:91]
    v_mfma_f32_16x16x32_bf16 v[120:123], v[212:215], v[184:187], v[120:123]
    v_mfma_f32_16x16x32_bf16 v[60:63], v[204:207], v[188:191], v[60:63]
    v_mfma_f32_16x16x32_bf16 v[92:95], v[208:211], v[188:191], v[92:95]
    v_mfma_f32_16x16x32_bf16 v[124:127], v[212:215], v[188:191], v[124:127]
    s_waitcnt vmcnt(9) lgkmcnt(0)
    v_mfma_f32_16x16x32_bf16 v[32:35], v[216:219], v[128:131], v[32:35]
    buffer_load_dwordx4 v[204:207], v2, s[24:27], s6 offen offset:0 sc1
    v_mfma_f32_16x16x32_bf16 v[64:67], v[220:223], v[128:131], v[64:67]
    buffer_load_dwordx4 v[208:211], v2, s[24:27], s6 offen offset:1024 sc1
    v_mfma_f32_16x16x32_bf16 v[96:99], v[224:227], v[128:131], v[96:99]
    buffer_load_dwordx4 v[212:215], v2, s[24:27], s6 offen offset:2048 sc1
    s_add_u32 s6, s6, 3072
    v_mfma_f32_16x16x32_bf16 v[36:39], v[216:219], v[132:135], v[36:39]
    ds_read_b64_tr_b16 v[160:161], v3 offset:27648
    v_mfma_f32_16x16x32_bf16 v[68:71], v[220:223], v[132:135], v[68:71]
    ds_read_b64_tr_b16 v[162:163], v3 offset:32256
    v_mfma_f32_16x16x32_bf16 v[100:103], v[224:227], v[132:135], v[100:103]
    ds_read_b64_tr_b16 v[164:165], v3 offset:27680
    v_mfma_f32_16x16x32_bf16 v[40:43], v[216:219], v[136:139], v[40:43]
    ds_read_b64_tr_b16 v[166:167], v3 offset:32288
    v_mfma_f32_16x16x32_bf16 v[72:75], v[220:223], v[136:139], v[72:75]
    ds_read_b64_tr_b16 v[168:169], v3 offset:27712
    v_mfma_f32_16x16x32_bf16 v[104:107], v[224:227], v[136:139], v[104:107]
    ds_read_b64_tr_b16 v[170:171], v3 offset:32320
    v_mfma_f32_16x16x32_bf16 v[44:47], v[216:219], v[140:143], v[44:47]
    ds_read_b64_tr_b16 v[172:173], v3 offset:27744
    v_mfma_f32_16x16x32_bf16 v[76:79], v[220:223], v[140:143], v[76:79]
    ds_read_b64_tr_b16 v[174:175], v3 offset:32352
    v_mfma_f32_16x16x32_bf16 v[108:111], v[224:227], v[140:143], v[108:111]
    ds_read_b64_tr_b16 v[176:177], v3 offset:27776
    v_mfma_f32_16x16x32_bf16 v[48:51], v[216:219], v[144:147], v[48:51]
    ds_read_b64_tr_b16 v[178:179], v3 offset:32384
    v_mfma_f32_16x16x32_bf16 v[80:83], v[220:223], v[144:147], v[80:83]
    ds_read_b64_tr_b16 v[180:181], v3 offset:27808
    v_mfma_f32_16x16x32_bf16 v[112:115], v[224:227], v[144:147], v[112:115]
    ds_read_b64_tr_b16 v[182:183], v3 offset:32416
    v_mfma_f32_16x16x32_bf16 v[52:55], v[216:219], v[148:151], v[52:55]
    ds_read_b64_tr_b16 v[184:185], v3 offset:27840
    v_mfma_f32_16x16x32_bf16 v[84:87], v[220:223], v[148:151], v[84:87]
    ds_read_b64_tr_b16 v[186:187], v3 offset:32448
    v_mfma_f32_16x16x32_bf16 v[116:119], v[224:227], v[148:151], v[116:119]
    ds_read_b64_tr_b16 v[188:189], v3 offset:27872
    v_mfma_f32_16x16x32_bf16 v[56:59], v[216:219], v[152:155], v[56:59]
    ds_read_b64_tr_b16 v[190:191], v3 offset:32480
    v_mfma_f32_16x16x32_bf16 v[88:91], v[220:223], v[152:155], v[88:91]
    v_mfma_f32_16x16x32_bf16 v[120:123], v[224:227], v[152:155], v[120:123]
    v_mfma_f32_16x16x32_bf16 v[60:63], v[216:219], v[156:159], v[60:63]
    v_mfma_f32_16x16x32_bf16 v[92:95], v[220:223], v[156:159], v[92:95]
    v_mfma_f32_16x16x32_bf16 v[124:127], v[224:227], v[156:159], v[124:127]
    s_waitcnt lgkmcnt(0)
    s_barrier
    s_waitcnt vmcnt(9) lgkmcnt(0)
    v_mfma_f32_16x16x32_bf16 v[32:35], v[228:231], v[160:163], v[32:35]
    buffer_load_dwordx4 v[216:219], v2, s[24:27], s6 offen offset:0 sc1
    v_mfma_f32_16x16x32_bf16 v[64:67], v[232:235], v[160:163], v[64:67]
    buffer_load_dwordx4 v[220:223], v2, s[24:27], s6 offen offset:1024 sc1
    v_mfma_f32_16x16x32_bf16 v[96:99], v[236:239], v[160:163], v[96:99]
    buffer_load_dwordx4 v[224:227], v2, s[24:27], s6 offen offset:2048 sc1
    s_add_u32 s6, s6, 3072
    v_mfma_f32_16x16x32_bf16 v[36:39], v[228:231], v[164:167], v[36:39]
    ds_read_b64_tr_b16 v[128:129], v3 offset:0
    v_mfma_f32_16x16x32_bf16 v[68:71], v[232:235], v[164:167], v[68:71]
    ds_read_b64_tr_b16 v[130:131], v3 offset:4608
    v_mfma_f32_16x16x32_bf16 v[100:103], v[236:239], v[164:167], v[100:103]
    ds_read_b64_tr_b16 v[132:133], v3 offset:32
    v_mfma_f32_16x16x32_bf16 v[40:43], v[228:231], v[168:171], v[40:43]
    ds_read_b64_tr_b16 v[134:135], v3 offset:4640
    v_mfma_f32_16x16x32_bf16 v[72:75], v[232:235], v[168:171], v[72:75]
    ds_read_b64_tr_b16 v[136:137], v3 offset:64
    v_mfma_f32_16x16x32_bf16 v[104:107], v[236:239], v[168:171], v[104:107]
    ds_read_b64_tr_b16 v[138:139], v3 offset:4672
    v_mfma_f32_16x16x32_bf16 v[44:47], v[228:231], v[172:175], v[44:47]
    ds_read_b64_tr_b16 v[140:141], v3 offset:96
    v_mfma_f32_16x16x32_bf16 v[76:79], v[232:235], v[172:175], v[76:79]
    ds_read_b64_tr_b16 v[142:143], v3 offset:4704
    v_mfma_f32_16x16x32_bf16 v[108:111], v[236:239], v[172:175], v[108:111]
    ds_read_b64_tr_b16 v[144:145], v3 offset:128
    v_mfma_f32_16x16x32_bf16 v[48:51], v[228:231], v[176:179], v[48:51]
    ds_read_b64_tr_b16 v[146:147], v3 offset:4736
    v_mfma_f32_16x16x32_bf16 v[80:83], v[232:235], v[176:179], v[80:83]
    ds_read_b64_tr_b16 v[148:149], v3 offset:160
    v_mfma_f32_16x16x32_bf16 v[112:115], v[236:239], v[176:179], v[112:115]
    ds_read_b64_tr_b16 v[150:151], v3 offset:4768
    v_mfma_f32_16x16x32_bf16 v[52:55], v[228:231], v[180:183], v[52:55]
    ds_read_b64_tr_b16 v[152:153], v3 offset:192
    v_mfma_f32_16x16x32_bf16 v[84:87], v[232:235], v[180:183], v[84:87]
    ds_read_b64_tr_b16 v[154:155], v3 offset:4800
    v_mfma_f32_16x16x32_bf16 v[116:119], v[236:239], v[180:183], v[116:119]
    ds_read_b64_tr_b16 v[156:157], v3 offset:224
    v_mfma_f32_16x16x32_bf16 v[56:59], v[228:231], v[184:187], v[56:59]
    ds_read_b64_tr_b16 v[158:159], v3 offset:4832
    v_mfma_f32_16x16x32_bf16 v[88:91], v[232:235], v[184:187], v[88:91]
    v_mfma_f32_16x16x32_bf16 v[120:123], v[236:239], v[184:187], v[120:123]
    v_mfma_f32_16x16x32_bf16 v[60:63], v[228:231], v[188:191], v[60:63]
    v_mfma_f32_16x16x32_bf16 v[92:95], v[232:235], v[188:191], v[92:95]
    v_mfma_f32_16x16x32_bf16 v[124:127], v[236:239], v[188:191], v[124:127]
    s_waitcnt vmcnt(9) lgkmcnt(0)
    v_mfma_f32_16x16x32_bf16 v[32:35], v[240:243], v[128:131], v[32:35]
    buffer_load_dwordx4 v[228:231], v2, s[24:27], s6 offen offset:0 sc1
    v_mfma_f32_16x16x32_bf16 v[64:67], v[244:247], v[128:131], v[64:67]
    buffer_load_dwordx4 v[232:235], v2, s[24:27], s6 offen offset:1024 sc1
    v_mfma_f32_16x16x32_bf16 v[96:99], v[248:251], v[128:131], v[96:99]
    buffer_load_dwordx4 v[236:239], v2, s[24:27], s6 offen offset:2048 sc1
    s_add_u32 s6, s6, 3072
    v_mfma_f32_16x16x32_bf16 v[36:39], v[240:243], v[132:135], v[36:39]
    ds_read_b64_tr_b16 v[160:161], v3 offset:9216
    v_mfma_f32_16x16x32_bf16 v[68:71], v[244:247], v[132:135], v[68:71]
    ds_read_b64_tr_b16 v[162:163], v3 offset:13824
    v_mfma_f32_16x16x32_bf16 v[100:103], v[248:251], v[132:135], v[100:103]
    ds_read_b64_tr_b16 v[164:165], v3 offset:9248
    v_mfma_f32_16x16x32_bf16 v[40:43], v[240:243], v[136:139], v[40:43]
    ds_read_b64_tr_b16 v[166:167], v3 offset:13856
    v_mfma_f32_16x16x32_bf16 v[72:75], v[244:247], v[136:139], v[72:75]
    ds_read_b64_tr_b16 v[168:169], v3 offset:9280
    v_mfma_f32_16x16x32_bf16 v[104:107], v[248:251], v[136:139], v[104:107]
    ds_read_b64_tr_b16 v[170:171], v3 offset:13888
    v_mfma_f32_16x16x32_bf16 v[44:47], v[240:243], v[140:143], v[44:47]
    ds_read_b64_tr_b16 v[172:173], v3 offset:9312
    v_mfma_f32_16x16x32_bf16 v[76:79], v[244:247], v[140:143], v[76:79]
    ds_read_b64_tr_b16 v[174:175], v3 offset:13920
    v_mfma_f32_16x16x32_bf16 v[108:111], v[248:251], v[140:143], v[108:111]
    ds_read_b64_tr_b16 v[176:177], v3 offset:9344
    v_mfma_f32_16x16x32_bf16 v[48:51], v[240:243], v[144:147], v[48:51]
    ds_read_b64_tr_b16 v[178:179], v3 offset:13952
    v_mfma_f32_16x16x32_bf16 v[80:83], v[244:247], v[144:147], v[80:83]
    ds_read_b64_tr_b16 v[180:181], v3 offset:9376
    v_mfma_f32_16x16x32_bf16 v[112:115], v[248:251], v[144:147], v[112:115]
    ds_read_b64_tr_b16 v[182:183], v3 offset:13984
    v_mfma_f32_16x16x32_bf16 v[52:55], v[240:243], v[148:151], v[52:55]
    ds_read_b64_tr_b16 v[184:185], v3 offset:9408
    v_mfma_f32_16x16x32_bf16 v[84:87], v[244:247], v[148:151], v[84:87]
    ds_read_b64_tr_b16 v[186:187], v3 offset:14016
    v_mfma_f32_16x16x32_bf16 v[116:119], v[248:251], v[148:151], v[116:119]
    ds_read_b64_tr_b16 v[188:189], v3 offset:9440
    v_mfma_f32_16x16x32_bf16 v[56:59], v[240:243], v[152:155], v[56:59]
    ds_read_b64_tr_b16 v[190:191], v3 offset:14048
    v_mfma_f32_16x16x32_bf16 v[88:91], v[244:247], v[152:155], v[88:91]
    v_mfma_f32_16x16x32_bf16 v[120:123], v[248:251], v[152:155], v[120:123]
    v_mfma_f32_16x16x32_bf16 v[60:63], v[240:243], v[156:159], v[60:63]
    v_mfma_f32_16x16x32_bf16 v[92:95], v[244:247], v[156:159], v[92:95]
    v_mfma_f32_16x16x32_bf16 v[124:127], v[248:251], v[156:159], v[124:127]
    s_waitcnt lgkmcnt(0)
    s_barrier
    s_waitcnt vmcnt(9) lgkmcnt(0)
    v_mfma_f32_16x16x32_bf16 v[32:35], v[192:195], v[160:163], v[32:35]
    buffer_load_dwordx4 v[240:243], v2, s[24:27], s6 offen offset:0 sc1
    v_mfma_f32_16x16x32_bf16 v[64:67], v[196:199], v[160:163], v[64:67]
    buffer_load_dwordx4 v[244:247], v2, s[24:27], s6 offen offset:1024 sc1
    v_mfma_f32_16x16x32_bf16 v[96:99], v[200:203], v[160:163], v[96:99]
    buffer_load_dwordx4 v[248:251], v2, s[24:27], s6 offen offset:2048 sc1
    s_add_u32 s6, s6, 3072
    v_mfma_f32_16x16x32_bf16 v[36:39], v[192:195], v[164:167], v[36:39]
    ds_read_b64_tr_b16 v[128:129], v3 offset:18432
    v_mfma_f32_16x16x32_bf16 v[68:71], v[196:199], v[164:167], v[68:71]
    ds_read_b64_tr_b16 v[130:131], v3 offset:23040
    v_mfma_f32_16x16x32_bf16 v[100:103], v[200:203], v[164:167], v[100:103]
    ds_read_b64_tr_b16 v[132:133], v3 offset:18464
    v_mfma_f32_16x16x32_bf16 v[40:43], v[192:195], v[168:171], v[40:43]
    ds_read_b64_tr_b16 v[134:135], v3 offset:23072
    v_mfma_f32_16x16x32_bf16 v[72:75], v[196:199], v[168:171], v[72:75]
    ds_read_b64_tr_b16 v[136:137], v3 offset:18496
    v_mfma_f32_16x16x32_bf16 v[104:107], v[200:203], v[168:171], v[104:107]
    ds_read_b64_tr_b16 v[138:139], v3 offset:23104
    v_mfma_f32_16x16x32_bf16 v[44:47], v[192:195], v[172:175], v[44:47]
    ds_read_b64_tr_b16 v[140:141], v3 offset:18528
    v_mfma_f32_16x16x32_bf16 v[76:79], v[196:199], v[172:175], v[76:79]
    ds_read_b64_tr_b16 v[142:143], v3 offset:23136
    v_mfma_f32_16x16x32_bf16 v[108:111], v[200:203], v[172:175], v[108:111]
    ds_read_b64_tr_b16 v[144:145], v3 offset:18560
    v_mfma_f32_16x16x32_bf16 v[48:51], v[192:195], v[176:179], v[48:51]
    ds_read_b64_tr_b16 v[146:147], v3 offset:23168
    v_mfma_f32_16x16x32_bf16 v[80:83], v[196:199], v[176:179], v[80:83]
    ds_read_b64_tr_b16 v[148:149], v3 offset:18592
    v_mfma_f32_16x16x32_bf16 v[112:115], v[200:203], v[176:179], v[112:115]
    ds_read_b64_tr_b16 v[150:151], v3 offset:23200
    v_mfma_f32_16x16x32_bf16 v[52:55], v[192:195], v[180:183], v[52:55]
    ds_read_b64_tr_b16 v[152:153], v3 offset:18624
    v_mfma_f32_16x16x32_bf16 v[84:87], v[196:199], v[180:183], v[84:87]
    ds_read_b64_tr_b16 v[154:155], v3 offset:23232
    v_mfma_f32_16x16x32_bf16 v[116:119], v[200:203], v[180:183], v[116:119]
    ds_read_b64_tr_b16 v[156:157], v3 offset:18656
    v_mfma_f32_16x16x32_bf16 v[56:59], v[192:195], v[184:187], v[56:59]
    ds_read_b64_tr_b16 v[158:159], v3 offset:23264
    v_mfma_f32_16x16x32_bf16 v[88:91], v[196:199], v[184:187], v[88:91]
    v_mfma_f32_16x16x32_bf16 v[120:123], v[200:203], v[184:187], v[120:123]
    v_mfma_f32_16x16x32_bf16 v[60:63], v[192:195], v[188:191], v[60:63]
    v_mfma_f32_16x16x32_bf16 v[92:95], v[196:199], v[188:191], v[92:95]
    v_mfma_f32_16x16x32_bf16 v[124:127], v[200:203], v[188:191], v[124:127]
    s_waitcnt vmcnt(9) lgkmcnt(0)
    v_mfma_f32_16x16x32_bf16 v[32:35], v[204:207], v[128:131], v[32:35]
    buffer_load_dwordx4 v[192:195], v2, s[24:27], s6 offen offset:0 sc1
    v_mfma_f32_16x16x32_bf16 v[64:67], v[208:211], v[128:131], v[64:67]
    buffer_load_dwordx4 v[196:199], v2, s[24:27], s6 offen offset:1024 sc1
    v_mfma_f32_16x16x32_bf16 v[96:99], v[212:215], v[128:131], v[96:99]
    buffer_load_dwordx4 v[200:203], v2, s[24:27], s6 offen offset:2048 sc1
    s_add_u32 s6, s6, 3072
    v_mfma_f32_16x16x32_bf16 v[36:39], v[204:207], v[132:135], v[36:39]
    ds_read_b64_tr_b16 v[160:161], v3 offset:27648
    v_mfma_f32_16x16x32_bf16 v[68:71], v[208:211], v[132:135], v[68:71]
    ds_read_b64_tr_b16 v[162:163], v3 offset:32256
    v_mfma_f32_16x16x32_bf16 v[100:103], v[212:215], v[132:135], v[100:103]
    ds_read_b64_tr_b16 v[164:165], v3 offset:27680
    v_mfma_f32_16x16x32_bf16 v[40:43], v[204:207], v[136:139], v[40:43]
    ds_read_b64_tr_b16 v[166:167], v3 offset:32288
    v_mfma_f32_16x16x32_bf16 v[72:75], v[208:211], v[136:139], v[72:75]
    ds_read_b64_tr_b16 v[168:169], v3 offset:27712
    v_mfma_f32_16x16x32_bf16 v[104:107], v[212:215], v[136:139], v[104:107]
    ds_read_b64_tr_b16 v[170:171], v3 offset:32320
    v_mfma_f32_16x16x32_bf16 v[44:47], v[204:207], v[140:143], v[44:47]
    ds_read_b64_tr_b16 v[172:173], v3 offset:27744
    v_mfma_f32_16x16x32_bf16 v[76:79], v[208:211], v[140:143], v[76:79]
    ds_read_b64_tr_b16 v[174:175], v3 offset:32352
    v_mfma_f32_16x16x32_bf16 v[108:111], v[212:215], v[140:143], v[108:111]
    ds_read_b64_tr_b16 v[176:177], v3 offset:27776
    v_mfma_f32_16x16x32_bf16 v[48:51], v[204:207], v[144:147], v[48:51]
    ds_read_b64_tr_b16 v[178:179], v3 offset:32384
    v_mfma_f32_16x16x32_bf16 v[80:83], v[208:211], v[144:147], v[80:83]
    ds_read_b64_tr_b16 v[180:181], v3 offset:27808
    v_mfma_f32_16x16x32_bf16 v[112:115], v[212:215], v[144:147], v[112:115]
    ds_read_b64_tr_b16 v[182:183], v3 offset:32416
    v_mfma_f32_16x16x32_bf16 v[52:55], v[204:207], v[148:151], v[52:55]
    ds_read_b64_tr_b16 v[184:185], v3 offset:27840
    v_mfma_f32_16x16x32_bf16 v[84:87], v[208:211], v[148:151], v[84:87]
    ds_read_b64_tr_b16 v[186:187], v3 offset:32448
    v_mfma_f32_16x16x32_bf16 v[116:119], v[212:215], v[148:151], v[116:119]
    ds_read_b64_tr_b16 v[188:189], v3 offset:27872
    v_mfma_f32_16x16x32_bf16 v[56:59], v[204:207], v[152:155], v[56:59]
    ds_read_b64_tr_b16 v[190:191], v3 offset:32480
    v_mfma_f32_16x16x32_bf16 v[88:91], v[208:211], v[152:155], v[88:91]
    v_mfma_f32_16x16x32_bf16 v[120:123], v[212:215], v[152:155], v[120:123]
    v_mfma_f32_16x16x32_bf16 v[60:63], v[204:207], v[156:159], v[60:63]
    v_mfma_f32_16x16x32_bf16 v[92:95], v[208:211], v[156:159], v[92:95]
    v_mfma_f32_16x16x32_bf16 v[124:127], v[212:215], v[156:159], v[124:127]
    s_waitcnt lgkmcnt(0)
    s_barrier
    s_waitcnt vmcnt(9) lgkmcnt(0)
    v_mfma_f32_16x16x32_bf16 v[32:35], v[216:219], v[160:163], v[32:35]
    buffer_load_dwordx4 v[204:207], v2, s[24:27], s6 offen offset:0 sc1
    v_mfma_f32_16x16x32_bf16 v[64:67], v[220:223], v[160:163], v[64:67]
    buffer_load_dwordx4 v[208:211], v2, s[24:27], s6 offen offset:1024 sc1
    v_mfma_f32_16x16x32_bf16 v[96:99], v[224:227], v[160:163], v[96:99]
    buffer_load_dwordx4 v[212:215], v2, s[24:27], s6 offen offset:2048 sc1
    s_add_u32 s6, s6, 3072
    v_mfma_f32_16x16x32_bf16 v[36:39], v[216:219], v[164:167], v[36:39]
    ds_read_b64_tr_b16 v[128:129], v3 offset:0
    v_mfma_f32_16x16x32_bf16 v[68:71], v[220:223], v[164:167], v[68:71]
    ds_read_b64_tr_b16 v[130:131], v3 offset:4608
    v_mfma_f32_16x16x32_bf16 v[100:103], v[224:227], v[164:167], v[100:103]
    ds_read_b64_tr_b16 v[132:133], v3 offset:32
    v_mfma_f32_16x16x32_bf16 v[40:43], v[216:219], v[168:171], v[40:43]
    ds_read_b64_tr_b16 v[134:135], v3 offset:4640
    v_mfma_f32_16x16x32_bf16 v[72:75], v[220:223], v[168:171], v[72:75]
    ds_read_b64_tr_b16 v[136:137], v3 offset:64
    v_mfma_f32_16x16x32_bf16 v[104:107], v[224:227], v[168:171], v[104:107]
    ds_read_b64_tr_b16 v[138:139], v3 offset:4672
    v_mfma_f32_16x16x32_bf16 v[44:47], v[216:219], v[172:175], v[44:47]
    ds_read_b64_tr_b16 v[140:141], v3 offset:96
    v_mfma_f32_16x16x32_bf16 v[76:79], v[220:223], v[172:175], v[76:79]
    ds_read_b64_tr_b16 v[142:143], v3 offset:4704
    v_mfma_f32_16x16x32_bf16 v[108:111], v[224:227], v[172:175], v[108:111]
    ds_read_b64_tr_b16 v[144:145], v3 offset:128
    v_mfma_f32_16x16x32_bf16 v[48:51], v[216:219], v[176:179], v[48:51]
    ds_read_b64_tr_b16 v[146:147], v3 offset:4736
    v_mfma_f32_16x16x32_bf16 v[80:83], v[220:223], v[176:179], v[80:83]
    ds_read_b64_tr_b16 v[148:149], v3 offset:160
    v_mfma_f32_16x16x32_bf16 v[112:115], v[224:227], v[176:179], v[112:115]
    ds_read_b64_tr_b16 v[150:151], v3 offset:4768
    v_mfma_f32_16x16x32_bf16 v[52:55], v[216:219], v[180:183], v[52:55]
    ds_read_b64_tr_b16 v[152:153], v3 offset:192
    v_mfma_f32_16x16x32_bf16 v[84:87], v[220:223], v[180:183], v[84:87]
    ds_read_b64_tr_b16 v[154:155], v3 offset:4800
    v_mfma_f32_16x16x32_bf16 v[116:119], v[224:227], v[180:183], v[116:119]
    ds_read_b64_tr_b16 v[156:157], v3 offset:224
    v_mfma_f32_16x16x32_bf16 v[56:59], v[216:219], v[184:187], v[56:59]
    ds_read_b64_tr_b16 v[158:159], v3 offset:4832
    v_mfma_f32_16x16x32_bf16 v[88:91], v[220:223], v[184:187], v[88:91]
    v_mfma_f32_16x16x32_bf16 v[120:123], v[224:227], v[184:187], v[120:123]
    v_mfma_f32_16x16x32_bf16 v[60:63], v[216:219], v[188:191], v[60:63]
    v_mfma_f32_16x16x32_bf16 v[92:95], v[220:223], v[188:191], v[92:95]
    v_mfma_f32_16x16x32_bf16 v[124:127], v[224:227], v[188:191], v[124:127]
    s_waitcnt vmcnt(9) lgkmcnt(0)
    v_mfma_f32_16x16x32_bf16 v[32:35], v[228:231], v[128:131], v[32:35]
    buffer_load_dwordx4 v[216:219], v2, s[24:27], s6 offen offset:0 sc1
    v_mfma_f32_16x16x32_bf16 v[64:67], v[232:235], v[128:131], v[64:67]
    buffer_load_dwordx4 v[220:223], v2, s[24:27], s6 offen offset:1024 sc1
    v_mfma_f32_16x16x32_bf16 v[96:99], v[236:239], v[128:131], v[96:99]
    buffer_load_dwordx4 v[224:227], v2, s[24:27], s6 offen offset:2048 sc1
    s_add_u32 s6, s6, 3072
    v_mfma_f32_16x16x32_bf16 v[36:39], v[228:231], v[132:135], v[36:39]
    ds_read_b64_tr_b16 v[160:161], v3 offset:9216
    v_mfma_f32_16x16x32_bf16 v[68:71], v[232:235], v[132:135], v[68:71]
    ds_read_b64_tr_b16 v[162:163], v3 offset:13824
    v_mfma_f32_16x16x32_bf16 v[100:103], v[236:239], v[132:135], v[100:103]
    ds_read_b64_tr_b16 v[164:165], v3 offset:9248
    v_mfma_f32_16x16x32_bf16 v[40:43], v[228:231], v[136:139], v[40:43]
    ds_read_b64_tr_b16 v[166:167], v3 offset:13856
    v_mfma_f32_16x16x32_bf16 v[72:75], v[232:235], v[136:139], v[72:75]
    ds_read_b64_tr_b16 v[168:169], v3 offset:9280
    v_mfma_f32_16x16x32_bf16 v[104:107], v[236:239], v[136:139], v[104:107]
    ds_read_b64_tr_b16 v[170:171], v3 offset:13888
    v_mfma_f32_16x16x32_bf16 v[44:47], v[228:231], v[140:143], v[44:47]
    ds_read_b64_tr_b16 v[172:173], v3 offset:9312
    v_mfma_f32_16x16x32_bf16 v[76:79], v[232:235], v[140:143], v[76:79]
    ds_read_b64_tr_b16 v[174:175], v3 offset:13920
    v_mfma_f32_16x16x32_bf16 v[108:111], v[236:239], v[140:143], v[108:111]
    ds_read_b64_tr_b16 v[176:177], v3 offset:9344
    v_mfma_f32_16x16x32_bf16 v[48:51], v[228:231], v[144:147], v[48:51]
    ds_read_b64_tr_b16 v[178:179], v3 offset:13952
    v_mfma_f32_16x16x32_bf16 v[80:83], v[232:235], v[144:147], v[80:83]
    ds_read_b64_tr_b16 v[180:181], v3 offset:9376
    v_mfma_f32_16x16x32_bf16 v[112:115], v[236:239], v[144:147], v[112:115]
    ds_read_b64_tr_b16 v[182:183], v3 offset:13984
    v_mfma_f32_16x16x32_bf16 v[52:55], v[228:231], v[148:151], v[52:55]
    ds_read_b64_tr_b16 v[184:185], v3 offset:9408
    v_mfma_f32_16x16x32_bf16 v[84:87], v[232:235], v[148:151], v[84:87]
    ds_read_b64_tr_b16 v[186:187], v3 offset:14016
    v_mfma_f32_16x16x32_bf16 v[116:119], v[236:239], v[148:151], v[116:119]
    ds_read_b64_tr_b16 v[188:189], v3 offset:9440
    v_mfma_f32_16x16x32_bf16 v[56:59], v[228:231], v[152:155], v[56:59]
    ds_read_b64_tr_b16 v[190:191], v3 offset:14048
    v_mfma_f32_16x16x32_bf16 v[88:91], v[232:235], v[152:155], v[88:91]
    v_mfma_f32_16x16x32_bf16 v[120:123], v[236:239], v[152:155], v[120:123]
    v_mfma_f32_16x16x32_bf16 v[60:63], v[228:231], v[156:159], v[60:63]
    v_mfma_f32_16x16x32_bf16 v[92:95], v[232:235], v[156:159], v[92:95]
    v_mfma_f32_16x16x32_bf16 v[124:127], v[236:239], v[156:159], v[124:127]
    s_waitcnt lgkmcnt(0)
    s_barrier
    s_waitcnt vmcnt(9) lgkmcnt(0)
    v_mfma_f32_16x16x32_bf16 v[32:35], v[240:243], v[160:163], v[32:35]
    buffer_load_dwordx4 v[228:231], v2, s[24:27], s6 offen offset:0 sc1
    v_mfma_f32_16x16x32_bf16 v[64:67], v[244:247], v[160:163], v[64:67]
    buffer_load_dwordx4 v[232:235], v2, s[24:27], s6 offen offset:1024 sc1
    v_mfma_f32_16x16x32_bf16 v[96:99], v[248:251], v[160:163], v[96:99]
    buffer_load_dwordx4 v[236:239], v2, s[24:27], s6 offen offset:2048 sc1
    s_add_u32 s6, s6, 3072
    v_mfma_f32_16x16x32_bf16 v[36:39], v[240:243], v[164:167], v[36:39]
    ds_read_b64_tr_b16 v[128:129], v3 offset:18432
    v_mfma_f32_16x16x32_bf16 v[68:71], v[244:247], v[164:167], v[68:71]
    ds_read_b64_tr_b16 v[130:131], v3 offset:23040
    v_mfma_f32_16x16x32_bf16 v[100:103], v[248:251], v[164:167], v[100:103]
    ds_read_b64_tr_b16 v[132:133], v3 offset:18464
    v_mfma_f32_16x16x32_bf16 v[40:43], v[240:243], v[168:171], v[40:43]
    ds_read_b64_tr_b16 v[134:135], v3 offset:23072
    v_mfma_f32_16x16x32_bf16 v[72:75], v[244:247], v[168:171], v[72:75]
    ds_read_b64_tr_b16 v[136:137], v3 offset:18496
    v_mfma_f32_16x16x32_bf16 v[104:107], v[248:251], v[168:171], v[104:107]
    ds_read_b64_tr_b16 v[138:139], v3 offset:23104
    v_mfma_f32_16x16x32_bf16 v[44:47], v[240:243], v[172:175], v[44:47]
    ds_read_b64_tr_b16 v[140:141], v3 offset:18528
    v_mfma_f32_16x16x32_bf16 v[76:79], v[244:247], v[172:175], v[76:79]
    ds_read_b64_tr_b16 v[142:143], v3 offset:23136
    v_mfma_f32_16x16x32_bf16 v[108:111], v[248:251], v[172:175], v[108:111]
    ds_read_b64_tr_b16 v[144:145], v3 offset:18560
    v_mfma_f32_16x16x32_bf16 v[48:51], v[240:243], v[176:179], v[48:51]
    ds_read_b64_tr_b16 v[146:147], v3 offset:23168
    v_mfma_f32_16x16x32_bf16 v[80:83], v[244:247], v[176:179], v[80:83]
    ds_read_b64_tr_b16 v[148:149], v3 offset:18592
    v_mfma_f32_16x16x32_bf16 v[112:115], v[248:251], v[176:179], v[112:115]
    ds_read_b64_tr_b16 v[150:151], v3 offset:23200
    v_mfma_f32_16x16x32_bf16 v[52:55], v[240:243], v[180:183], v[52:55]
    ds_read_b64_tr_b16 v[152:153], v3 offset:18624
    v_mfma_f32_16x16x32_bf16 v[84:87], v[244:247], v[180:183], v[84:87]
    ds_read_b64_tr_b16 v[154:155], v3 offset:23232
    v_mfma_f32_16x16x32_bf16 v[116:119], v[248:251], v[180:183], v[116:119]
    ds_read_b64_tr_b16 v[156:157], v3 offset:18656
    v_mfma_f32_16x16x32_bf16 v[56:59], v[240:243], v[184:187], v[56:59]
    ds_read_b64_tr_b16 v[158:159], v3 offset:23264
    v_mfma_f32_16x16x32_bf16 v[88:91], v[244:247], v[184:187], v[88:91]
    v_mfma_f32_16x16x32_bf16 v[120:123], v[248:251], v[184:187], v[120:123]
    v_mfma_f32_16x16x32_bf16 v[60:63], v[240:243], v[188:191], v[60:63]
    v_mfma_f32_16x16x32_bf16 v[92:95], v[244:247], v[188:191], v[92:95]
    v_mfma_f32_16x16x32_bf16 v[124:127], v[248:251], v[188:191], v[124:127]
    s_waitcnt vmcnt(9) lgkmcnt(0)
    v_mfma_f32_16x16x32_bf16 v[32:35], v[192:195], v[128:131], v[32:35]
    buffer_load_dwordx4 v[240:243], v2, s[24:27], s6 offen offset:0 sc1
    v_mfma_f32_16x16x32_bf16 v[64:67], v[196:199], v[128:131], v[64:67]
    buffer_load_dwordx4 v[244:247], v2, s[24:27], s6 offen offset:1024 sc1
    v_mfma_f32_16x16x32_bf16 v[96:99], v[200:203], v[128:131], v[96:99]
    buffer_load_dwordx4 v[248:251], v2, s[24:27], s6 offen offset:2048 sc1
    s_add_u32 s6, s6, 3072
    v_mfma_f32_16x16x32_bf16 v[36:39], v[192:195], v[132:135], v[36:39]
    ds_read_b64_tr_b16 v[160:161], v3 offset:27648
    v_mfma_f32_16x16x32_bf16 v[68:71], v[196:199], v[132:135], v[68:71]
    ds_read_b64_tr_b16 v[162:163], v3 offset:32256
    v_mfma_f32_16x16x32_bf16 v[100:103], v[200:203], v[132:135], v[100:103]
    ds_read_b64_tr_b16 v[164:165], v3 offset:27680
    v_mfma_f32_16x16x32_bf16 v[40:43], v[192:195], v[136:139], v[40:43]
    ds_read_b64_tr_b16 v[166:167], v3 offset:32288
    v_mfma_f32_16x16x32_bf16 v[72:75], v[196:199], v[136:139], v[72:75]
    ds_read_b64_tr_b16 v[168:169], v3 offset:27712
    v_mfma_f32_16x16x32_bf16 v[104:107], v[200:203], v[136:139], v[104:107]
    ds_read_b64_tr_b16 v[170:171], v3 offset:32320
    v_mfma_f32_16x16x32_bf16 v[44:47], v[192:195], v[140:143], v[44:47]
    ds_read_b64_tr_b16 v[172:173], v3 offset:27744
    v_mfma_f32_16x16x32_bf16 v[76:79], v[196:199], v[140:143], v[76:79]
    ds_read_b64_tr_b16 v[174:175], v3 offset:32352
    v_mfma_f32_16x16x32_bf16 v[108:111], v[200:203], v[140:143], v[108:111]
    ds_read_b64_tr_b16 v[176:177], v3 offset:27776
    v_mfma_f32_16x16x32_bf16 v[48:51], v[192:195], v[144:147], v[48:51]
    ds_read_b64_tr_b16 v[178:179], v3 offset:32384
    v_mfma_f32_16x16x32_bf16 v[80:83], v[196:199], v[144:147], v[80:83]
    ds_read_b64_tr_b16 v[180:181], v3 offset:27808
    v_mfma_f32_16x16x32_bf16 v[112:115], v[200:203], v[144:147], v[112:115]
    ds_read_b64_tr_b16 v[182:183], v3 offset:32416
    v_mfma_f32_16x16x32_bf16 v[52:55], v[192:195], v[148:151], v[52:55]
    ds_read_b64_tr_b16 v[184:185], v3 offset:27840
    v_mfma_f32_16x16x32_bf16 v[84:87], v[196:199], v[148:151], v[84:87]
    ds_read_b64_tr_b16 v[186:187], v3 offset:32448
    v_mfma_f32_16x16x32_bf16 v[116:119], v[200:203], v[148:151], v[116:119]
    ds_read_b64_tr_b16 v[188:189], v3 offset:27872
    v_mfma_f32_16x16x32_bf16 v[56:59], v[192:195], v[152:155], v[56:59]
    ds_read_b64_tr_b16 v[190:191], v3 offset:32480
    v_mfma_f32_16x16x32_bf16 v[88:91], v[196:199], v[152:155], v[88:91]
    v_mfma_f32_16x16x32_bf16 v[120:123], v[200:203], v[152:155], v[120:123]
    v_mfma_f32_16x16x32_bf16 v[60:63], v[192:195], v[156:159], v[60:63]
    v_mfma_f32_16x16x32_bf16 v[92:95], v[196:199], v[156:159], v[92:95]
    v_mfma_f32_16x16x32_bf16 v[124:127], v[200:203], v[156:159], v[124:127]
    s_waitcnt lgkmcnt(0)
    s_barrier
    s_waitcnt vmcnt(9) lgkmcnt(0)
    v_mfma_f32_16x16x32_bf16 v[32:35], v[204:207], v[160:163], v[32:35]
    buffer_load_dwordx4 v[192:195], v2, s[24:27], s6 offen offset:0 sc1
    v_mfma_f32_16x16x32_bf16 v[64:67], v[208:211], v[160:163], v[64:67]
    buffer_load_dwordx4 v[196:199], v2, s[24:27], s6 offen offset:1024 sc1
    v_mfma_f32_16x16x32_bf16 v[96:99], v[212:215], v[160:163], v[96:99]
    buffer_load_dwordx4 v[200:203], v2, s[24:27], s6 offen offset:2048 sc1
    s_add_u32 s6, s6, 3072
    v_mfma_f32_16x16x32_bf16 v[36:39], v[204:207], v[164:167], v[36:39]
    ds_read_b64_tr_b16 v[128:129], v3 offset:0
    v_mfma_f32_16x16x32_bf16 v[68:71], v[208:211], v[164:167], v[68:71]
    ds_read_b64_tr_b16 v[130:131], v3 offset:4608
    v_mfma_f32_16x16x32_bf16 v[100:103], v[212:215], v[164:167], v[100:103]
    ds_read_b64_tr_b16 v[132:133], v3 offset:32
    v_mfma_f32_16x16x32_bf16 v[40:43], v[204:207], v[168:171], v[40:43]
    ds_read_b64_tr_b16 v[134:135], v3 offset:4640
    v_mfma_f32_16x16x32_bf16 v[72:75], v[208:211], v[168:171], v[72:75]
    ds_read_b64_tr_b16 v[136:137], v3 offset:64
    v_mfma_f32_16x16x32_bf16 v[104:107], v[212:215], v[168:171], v[104:107]
    ds_read_b64_tr_b16 v[138:139], v3 offset:4672
    v_mfma_f32_16x16x32_bf16 v[44:47], v[204:207], v[172:175], v[44:47]
    ds_read_b64_tr_b16 v[140:141], v3 offset:96
    v_mfma_f32_16x16x32_bf16 v[76:79], v[208:211], v[172:175], v[76:79]
    ds_read_b64_tr_b16 v[142:143], v3 offset:4704
    v_mfma_f32_16x16x32_bf16 v[108:111], v[212:215], v[172:175], v[108:111]
    ds_read_b64_tr_b16 v[144:145], v3 offset:128
    v_mfma_f32_16x16x32_bf16 v[48:51], v[204:207], v[176:179], v[48:51]
    ds_read_b64_tr_b16 v[146:147], v3 offset:4736
    v_mfma_f32_16x16x32_bf16 v[80:83], v[208:211], v[176:179], v[80:83]
    ds_read_b64_tr_b16 v[148:149], v3 offset:160
    v_mfma_f32_16x16x32_bf16 v[112:115], v[212:215], v[176:179], v[112:115]
    ds_read_b64_tr_b16 v[150:151], v3 offset:4768
    v_mfma_f32_16x16x32_bf16 v[52:55], v[204:207], v[180:183], v[52:55]
    ds_read_b64_tr_b16 v[152:153], v3 offset:192
    v_mfma_f32_16x16x32_bf16 v[84:87], v[208:211], v[180:183], v[84:87]
    ds_read_b64_tr_b16 v[154:155], v3 offset:4800
    v_mfma_f32_16x16x32_bf16 v[116:119], v[212:215], v[180:183], v[116:119]
    ds_read_b64_tr_b16 v[156:157], v3 offset:224
    v_mfma_f32_16x16x32_bf16 v[56:59], v[204:207], v[184:187], v[56:59]
    ds_read_b64_tr_b16 v[158:159], v3 offset:4832
    v_mfma_f32_16x16x32_bf16 v[88:91], v[208:211], v[184:187], v[88:91]
    v_mfma_f32_16x16x32_bf16 v[120:123], v[212:215], v[184:187], v[120:123]
    v_mfma_f32_16x16x32_bf16 v[60:63], v[204:207], v[188:191], v[60:63]
    v_mfma_f32_16x16x32_bf16 v[92:95], v[208:211], v[188:191], v[92:95]
    v_mfma_f32_16x16x32_bf16 v[124:127], v[212:215], v[188:191], v[124:127]
    s_waitcnt vmcnt(9) lgkmcnt(0)
    v_mfma_f32_16x16x32_bf16 v[32:35], v[216:219], v[128:131], v[32:35]
    ds_read_b64_tr_b16 v[160:161], v3 offset:9216
    v_mfma_f32_16x16x32_bf16 v[64:67], v[220:223], v[128:131], v[64:67]
    ds_read_b64_tr_b16 v[162:163], v3 offset:13824
    v_mfma_f32_16x16x32_bf16 v[96:99], v[224:227], v[128:131], v[96:99]
    ds_read_b64_tr_b16 v[164:165], v3 offset:9248
    v_mfma_f32_16x16x32_bf16 v[36:39], v[216:219], v[132:135], v[36:39]
    ds_read_b64_tr_b16 v[166:167], v3 offset:13856
    v_mfma_f32_16x16x32_bf16 v[68:71], v[220:223], v[132:135], v[68:71]
    ds_read_b64_tr_b16 v[168:169], v3 offset:9280
    v_mfma_f32_16x16x32_bf16 v[100:103], v[224:227], v[132:135], v[100:103]
    ds_read_b64_tr_b16 v[170:171], v3 offset:13888
    v_mfma_f32_16x16x32_bf16 v[40:43], v[216:219], v[136:139], v[40:43]
    ds_read_b64_tr_b16 v[172:173], v3 offset:9312
    v_mfma_f32_16x16x32_bf16 v[72:75], v[220:223], v[136:139], v[72:75]
    ds_read_b64_tr_b16 v[174:175], v3 offset:13920
    v_mfma_f32_16x16x32_bf16 v[104:107], v[224:227], v[136:139], v[104:107]
    ds_read_b64_tr_b16 v[176:177], v3 offset:9344
    v_mfma_f32_16x16x32_bf16 v[44:47], v[216:219], v[140:143], v[44:47]
    ds_read_b64_tr_b16 v[178:179], v3 offset:13952
    v_mfma_f32_16x16x32_bf16 v[76:79], v[220:223], v[140:143], v[76:79]
    ds_read_b64_tr_b16 v[180:181], v3 offset:9376
    v_mfma_f32_16x16x32_bf16 v[108:111], v[224:227], v[140:143], v[108:111]
    ds_read_b64_tr_b16 v[182:183], v3 offset:13984
    v_mfma_f32_16x16x32_bf16 v[48:51], v[216:219], v[144:147], v[48:51]
    ds_read_b64_tr_b16 v[184:185], v3 offset:9408
    v_mfma_f32_16x16x32_bf16 v[80:83], v[220:223], v[144:147], v[80:83]
    ds_read_b64_tr_b16 v[186:187], v3 offset:14016
    v_mfma_f32_16x16x32_bf16 v[112:115], v[224:227], v[144:147], v[112:115]
    ds_read_b64_tr_b16 v[188:189], v3 offset:9440
    v_mfma_f32_16x16x32_bf16 v[52:55], v[216:219], v[148:151], v[52:55]
    ds_read_b64_tr_b16 v[190:191], v3 offset:14048
    v_mfma_f32_16x16x32_bf16 v[84:87], v[220:223], v[148:151], v[84:87]
    v_mfma_f32_16x16x32_bf16 v[116:119], v[224:227], v[148:151], v[116:119]
    v_mfma_f32_16x16x32_bf16 v[56:59], v[216:219], v[152:155], v[56:59]
    v_mfma_f32_16x16x32_bf16 v[88:91], v[220:223], v[152:155], v[88:91]
    v_mfma_f32_16x16x32_bf16 v[120:123], v[224:227], v[152:155], v[120:123]
    v_mfma_f32_16x16x32_bf16 v[60:63], v[216:219], v[156:159], v[60:63]
    v_mfma_f32_16x16x32_bf16 v[92:95], v[220:223], v[156:159], v[92:95]
    v_mfma_f32_16x16x32_bf16 v[124:127], v[224:227], v[156:159], v[124:127]
    s_waitcnt lgkmcnt(0)
    s_barrier
    s_waitcnt vmcnt(6) lgkmcnt(0)
    v_mfma_f32_16x16x32_bf16 v[32:35], v[228:231], v[160:163], v[32:35]
    ds_read_b64_tr_b16 v[128:129], v3 offset:18432
    v_mfma_f32_16x16x32_bf16 v[64:67], v[232:235], v[160:163], v[64:67]
    ds_read_b64_tr_b16 v[130:131], v3 offset:23040
    v_mfma_f32_16x16x32_bf16 v[96:99], v[236:239], v[160:163], v[96:99]
    ds_read_b64_tr_b16 v[132:133], v3 offset:18464
    v_mfma_f32_16x16x32_bf16 v[36:39], v[228:231], v[164:167], v[36:39]
    ds_read_b64_tr_b16 v[134:135], v3 offset:23072
    v_mfma_f32_16x16x32_bf16 v[68:71], v[232:235], v[164:167], v[68:71]
    ds_read_b64_tr_b16 v[136:137], v3 offset:18496
    v_mfma_f32_16x16x32_bf16 v[100:103], v[236:239], v[164:167], v[100:103]
    ds_read_b64_tr_b16 v[138:139], v3 offset:23104
    v_mfma_f32_16x16x32_bf16 v[40:43], v[228:231], v[168:171], v[40:43]
    ds_read_b64_tr_b16 v[140:141], v3 offset:18528
    v_mfma_f32_16x16x32_bf16 v[72:75], v[232:235], v[168:171], v[72:75]
    ds_read_b64_tr_b16 v[142:143], v3 offset:23136
    v_mfma_f32_16x16x32_bf16 v[104:107], v[236:239], v[168:171], v[104:107]
    ds_read_b64_tr_b16 v[144:145], v3 offset:18560
    v_mfma_f32_16x16x32_bf16 v[44:47], v[228:231], v[172:175], v[44:47]
    ds_read_b64_tr_b16 v[146:147], v3 offset:23168
    v_mfma_f32_16x16x32_bf16 v[76:79], v[232:235], v[172:175], v[76:79]
    ds_read_b64_tr_b16 v[148:149], v3 offset:18592
    v_mfma_f32_16x16x32_bf16 v[108:111], v[236:239], v[172:175], v[108:111]
    ds_read_b64_tr_b16 v[150:151], v3 offset:23200
    v_mfma_f32_16x16x32_bf16 v[48:51], v[228:231], v[176:179], v[48:51]
    ds_read_b64_tr_b16 v[152:153], v3 offset:18624
    v_mfma_f32_16x16x32_bf16 v[80:83], v[232:235], v[176:179], v[80:83]
    ds_read_b64_tr_b16 v[154:155], v3 offset:23232
    v_mfma_f32_16x16x32_bf16 v[112:115], v[236:239], v[176:179], v[112:115]
    ds_read_b64_tr_b16 v[156:157], v3 offset:18656
    v_mfma_f32_16x16x32_bf16 v[52:55], v[228:231], v[180:183], v[52:55]
    ds_read_b64_tr_b16 v[158:159], v3 offset:23264
    v_mfma_f32_16x16x32_bf16 v[84:87], v[232:235], v[180:183], v[84:87]
    v_mfma_f32_16x16x32_bf16 v[116:119], v[236:239], v[180:183], v[116:119]
    v_mfma_f32_16x16x32_bf16 v[56:59], v[228:231], v[184:187], v[56:59]
    v_mfma_f32_16x16x32_bf16 v[88:91], v[232:235], v[184:187], v[88:91]
    v_mfma_f32_16x16x32_bf16 v[120:123], v[236:239], v[184:187], v[120:123]
    v_mfma_f32_16x16x32_bf16 v[60:63], v[228:231], v[188:191], v[60:63]
    v_mfma_f32_16x16x32_bf16 v[92:95], v[232:235], v[188:191], v[92:95]
    v_mfma_f32_16x16x32_bf16 v[124:127], v[236:239], v[188:191], v[124:127]
    s_waitcnt vmcnt(3) lgkmcnt(0)
    v_mfma_f32_16x16x32_bf16 v[32:35], v[240:243], v[128:131], v[32:35]
    ds_read_b64_tr_b16 v[160:161], v3 offset:27648
    v_mfma_f32_16x16x32_bf16 v[64:67], v[244:247], v[128:131], v[64:67]
    ds_read_b64_tr_b16 v[162:163], v3 offset:32256
    v_mfma_f32_16x16x32_bf16 v[96:99], v[248:251], v[128:131], v[96:99]
    ds_read_b64_tr_b16 v[164:165], v3 offset:27680
    v_mfma_f32_16x16x32_bf16 v[36:39], v[240:243], v[132:135], v[36:39]
    ds_read_b64_tr_b16 v[166:167], v3 offset:32288
    v_mfma_f32_16x16x32_bf16 v[68:71], v[244:247], v[132:135], v[68:71]
    ds_read_b64_tr_b16 v[168:169], v3 offset:27712
    v_mfma_f32_16x16x32_bf16 v[100:103], v[248:251], v[132:135], v[100:103]
    ds_read_b64_tr_b16 v[170:171], v3 offset:32320
    v_mfma_f32_16x16x32_bf16 v[40:43], v[240:243], v[136:139], v[40:43]
    ds_read_b64_tr_b16 v[172:173], v3 offset:27744
    v_mfma_f32_16x16x32_bf16 v[72:75], v[244:247], v[136:139], v[72:75]
    ds_read_b64_tr_b16 v[174:175], v3 offset:32352
    v_mfma_f32_16x16x32_bf16 v[104:107], v[248:251], v[136:139], v[104:107]
    ds_read_b64_tr_b16 v[176:177], v3 offset:27776
    v_mfma_f32_16x16x32_bf16 v[44:47], v[240:243], v[140:143], v[44:47]
    ds_read_b64_tr_b16 v[178:179], v3 offset:32384
    v_mfma_f32_16x16x32_bf16 v[76:79], v[244:247], v[140:143], v[76:79]
    ds_read_b64_tr_b16 v[180:181], v3 offset:27808
    v_mfma_f32_16x16x32_bf16 v[108:111], v[248:251], v[140:143], v[108:111]
    ds_read_b64_tr_b16 v[182:183], v3 offset:32416
    v_mfma_f32_16x16x32_bf16 v[48:51], v[240:243], v[144:147], v[48:51]
    ds_read_b64_tr_b16 v[184:185], v3 offset:27840
    v_mfma_f32_16x16x32_bf16 v[80:83], v[244:247], v[144:147], v[80:83]
    ds_read_b64_tr_b16 v[186:187], v3 offset:32448
    v_mfma_f32_16x16x32_bf16 v[112:115], v[248:251], v[144:147], v[112:115]
    ds_read_b64_tr_b16 v[188:189], v3 offset:27872
    v_mfma_f32_16x16x32_bf16 v[52:55], v[240:243], v[148:151], v[52:55]
    ds_read_b64_tr_b16 v[190:191], v3 offset:32480
    v_mfma_f32_16x16x32_bf16 v[84:87], v[244:247], v[148:151], v[84:87]
    v_mfma_f32_16x16x32_bf16 v[116:119], v[248:251], v[148:151], v[116:119]
    v_mfma_f32_16x16x32_bf16 v[56:59], v[240:243], v[152:155], v[56:59]
    v_mfma_f32_16x16x32_bf16 v[88:91], v[244:247], v[152:155], v[88:91]
    v_mfma_f32_16x16x32_bf16 v[120:123], v[248:251], v[152:155], v[120:123]
    v_mfma_f32_16x16x32_bf16 v[60:63], v[240:243], v[156:159], v[60:63]
    v_mfma_f32_16x16x32_bf16 v[92:95], v[244:247], v[156:159], v[92:95]
    v_mfma_f32_16x16x32_bf16 v[124:127], v[248:251], v[156:159], v[124:127]
    s_waitcnt vmcnt(0) lgkmcnt(0)
    v_mfma_f32_16x16x32_bf16 v[52:55], v[192:195], v[180:183], v[52:55]
    v_mfma_f32_16x16x32_bf16 v[84:87], v[196:199], v[180:183], v[84:87]
    v_mfma_f32_16x16x32_bf16 v[116:119], v[200:203], v[180:183], v[116:119]
    v_mfma_f32_16x16x32_bf16 v[56:59], v[192:195], v[184:187], v[56:59]
    v_mfma_f32_16x16x32_bf16 v[88:91], v[196:199], v[184:187], v[88:91]
    v_mfma_f32_16x16x32_bf16 v[120:123], v[200:203], v[184:187], v[120:123]
    v_mfma_f32_16x16x32_bf16 v[60:63], v[192:195], v[188:191], v[60:63]
    v_mfma_f32_16x16x32_bf16 v[92:95], v[196:199], v[188:191], v[92:95]
    v_mfma_f32_16x16x32_bf16 v[124:127], v[200:203], v[188:191], v[124:127]
    v_mfma_f32_16x16x32_bf16 v[32:35], v[192:195], v[160:163], v[32:35]
    v_mfma_f32_16x16x32_bf16 v[64:67], v[196:199], v[160:163], v[64:67]
    v_mfma_f32_16x16x32_bf16 v[96:99], v[200:203], v[160:163], v[96:99]
    v_mfma_f32_16x16x32_bf16 v[36:39], v[192:195], v[164:167], v[36:39]
    v_mfma_f32_16x16x32_bf16 v[68:71], v[196:199], v[164:167], v[68:71]
    v_mfma_f32_16x16x32_bf16 v[100:103], v[200:203], v[164:167], v[100:103]
    v_mfma_f32_16x16x32_bf16 v[40:43], v[192:195], v[168:171], v[40:43]
    v_mfma_f32_16x16x32_bf16 v[72:75], v[196:199], v[168:171], v[72:75]
    v_mfma_f32_16x16x32_bf16 v[104:107], v[200:203], v[168:171], v[104:107]
    v_mfma_f32_16x16x32_bf16 v[44:47], v[192:195], v[172:175], v[44:47]
    v_mfma_f32_16x16x32_bf16 v[76:79], v[196:199], v[172:175], v[76:79]
    v_mfma_f32_16x16x32_bf16 v[108:111], v[200:203], v[172:175], v[108:111]
    v_mfma_f32_16x16x32_bf16 v[48:51], v[192:195], v[176:179], v[48:51]
    v_mfma_f32_16x16x32_bf16 v[80:83], v[196:199], v[176:179], v[80:83]
    v_mfma_f32_16x16x32_bf16 v[112:115], v[200:203], v[176:179], v[112:115]
    s_mul_i32 s31, s5, 9216
    v_add_u32 v4, s31, v9
    v_and_b32 v3, 15, v1
    v_lshlrev_b32 v3, 4, v3
    v_add_u32 v3, 33792, v3
    ds_write_b128 v4, v[52:55] offset:51200
    ds_write_b128 v4, v[56:59] offset:52224
    ds_write_b128 v4, v[60:63] offset:53248
    ds_write_b128 v4, v[84:87] offset:54272
    ds_write_b128 v4, v[88:91] offset:55296
    ds_write_b128 v4, v[92:95] offset:56320
    ds_write_b128 v4, v[116:119] offset:57344
    ds_write_b128 v4, v[120:123] offset:58368
    ds_write_b128 v4, v[124:127] offset:59392
    s_mul_i32 s31, s5, 3072
    v_add_u32 v4, s31, v9
    s_waitcnt lgkmcnt(0)
    s_barrier
    ds_read_b128 v[128:131], v3 offset:36864
    ds_read_b128 v[132:135], v3 offset:37120
    ds_read_b128 v[136:139], v3 offset:37376
    ds_read_b128 v[140:143], v3 offset:37632
    ds_read_b128 v[144:147], v3 offset:37888
    ds_read_b128 v[176:179], v4 offset:38912
    ds_read_b128 v[180:183], v4 offset:39936
    ds_read_b128 v[184:187], v4 offset:40960
    s_waitcnt lgkmcnt(0)
    s_add_u32 s10, s7, 0
    s_lshr_b32 s11, s10, 2
    s_and_b32 s10, s10, 3
    s_lshl_b32 s11, s11, 10
    s_lshl_b32 s10, s10, 2
    s_add_u32 s10, s10, s11
    v_add_u32 v7, s10, v9
    v_pk_fma_f32 v[32:33], v[176:177], v[128:129], v[32:33] op_sel_hi:[1,0,1]
    v_pk_fma_f32 v[34:35], v[178:179], v[128:129], v[34:35] op_sel_hi:[1,0,1]
    v_pk_fma_f32 v[36:37], v[176:177], v[132:133], v[36:37] op_sel_hi:[1,0,1]
    v_pk_fma_f32 v[38:39], v[178:179], v[132:133], v[38:39] op_sel_hi:[1,0,1]
    v_pk_fma_f32 v[40:41], v[176:177], v[136:137], v[40:41] op_sel_hi:[1,0,1]
    v_pk_fma_f32 v[42:43], v[178:179], v[136:137], v[42:43] op_sel_hi:[1,0,1]
    v_pk_fma_f32 v[44:45], v[176:177], v[140:141], v[44:45] op_sel_hi:[1,0,1]
    v_pk_fma_f32 v[46:47], v[178:179], v[140:141], v[46:47] op_sel_hi:[1,0,1]
    v_pk_fma_f32 v[48:49], v[176:177], v[144:145], v[48:49] op_sel_hi:[1,0,1]
    v_pk_fma_f32 v[50:51], v[178:179], v[144:145], v[50:51] op_sel_hi:[1,0,1]
    v_pk_mul_f32 v[160:161], v[32:33], v[128:129] op_sel:[0,1] op_sel_hi:[1,1]
    v_pk_mul_f32 v[162:163], v[36:37], v[132:133] op_sel:[0,1] op_sel_hi:[1,1]
    v_pk_mul_f32 v[164:165], v[40:41], v[136:137] op_sel:[0,1] op_sel_hi:[1,1]
    v_pk_mul_f32 v[166:167], v[44:45], v[140:141] op_sel:[0,1] op_sel_hi:[1,1]
    v_pk_mul_f32 v[168:169], v[48:49], v[144:145] op_sel:[0,1] op_sel_hi:[1,1]
    v_exp_f32 v160, v160
    v_exp_f32 v161, v161
    v_exp_f32 v162, v162
    v_exp_f32 v163, v163
    v_exp_f32 v164, v164
    v_exp_f32 v165, v165
    v_exp_f32 v166, v166
    v_exp_f32 v167, v167
    v_exp_f32 v168, v168
    v_exp_f32 v169, v169
    v_pk_mul_f32 v[32:33], v[32:33], v[34:35]
    v_pk_add_f32 v[160:161], v[160:161], 1.0 op_sel_hi:[1,0]
    v_pk_mul_f32 v[36:37], v[36:37], v[38:39]
    v_pk_add_f32 v[162:163], v[162:163], 1.0 op_sel_hi:[1,0]
    v_pk_mul_f32 v[40:41], v[40:41], v[42:43]
    v_pk_add_f32 v[164:165], v[164:165], 1.0 op_sel_hi:[1,0]
    v_pk_mul_f32 v[44:45], v[44:45], v[46:47]
    v_pk_add_f32 v[166:167], v[166:167], 1.0 op_sel_hi:[1,0]
    v_pk_mul_f32 v[48:49], v[48:49], v[50:51]
    v_pk_add_f32 v[168:169], v[168:169], 1.0 op_sel_hi:[1,0]
    v_rcp_f32 v160, v160
    v_rcp_f32 v161, v161
    v_rcp_f32 v162, v162
    v_rcp_f32 v163, v163
    v_rcp_f32 v164, v164
    v_rcp_f32 v165, v165
    v_rcp_f32 v166, v166
    v_rcp_f32 v167, v167
    v_rcp_f32 v168, v168
    v_rcp_f32 v169, v169
    v_pk_mul_f32 v[32:33], v[32:33], v[130:131] op_sel_hi:[1,0]
    v_pk_mul_f32 v[36:37], v[36:37], v[134:135] op_sel_hi:[1,0]
    v_pk_mul_f32 v[40:41], v[40:41], v[138:139] op_sel_hi:[1,0]
    v_pk_mul_f32 v[44:45], v[44:45], v[142:143] op_sel_hi:[1,0]
    v_pk_mul_f32 v[48:49], v[48:49], v[146:147] op_sel_hi:[1,0]
    v_pk_mul_f32 v[32:33], v[32:33], v[160:161]
    v_pk_mul_f32 v[36:37], v[36:37], v[162:163]
    v_pk_mul_f32 v[40:41], v[40:41], v[164:165]
    v_pk_mul_f32 v[44:45], v[44:45], v[166:167]
    v_pk_mul_f32 v[48:49], v[48:49], v[168:169]
    v_cvt_pk_bf16_f32 v34, v32, v33
    ds_write_b32 v7, v34 offset:0
    v_cvt_pk_bf16_f32 v38, v36, v37
    ds_write_b32 v7, v38 offset:3072
    v_cvt_pk_bf16_f32 v42, v40, v41
    ds_write_b32 v7, v42 offset:6144
    v_cvt_pk_bf16_f32 v46, v44, v45
    ds_write_b32 v7, v46 offset:9216
    v_cvt_pk_bf16_f32 v50, v48, v49
    ds_write_b32 v7, v50 offset:12288
    s_add_u32 s10, s7, 1
    s_lshr_b32 s11, s10, 2
    s_and_b32 s10, s10, 3
    s_lshl_b32 s11, s11, 10
    s_lshl_b32 s10, s10, 2
    s_add_u32 s10, s10, s11
    v_add_u32 v7, s10, v9
    v_pk_fma_f32 v[64:65], v[180:181], v[128:129], v[64:65] op_sel_hi:[1,0,1]
    v_pk_fma_f32 v[66:67], v[182:183], v[128:129], v[66:67] op_sel_hi:[1,0,1]
    v_pk_fma_f32 v[68:69], v[180:181], v[132:133], v[68:69] op_sel_hi:[1,0,1]
    v_pk_fma_f32 v[70:71], v[182:183], v[132:133], v[70:71] op_sel_hi:[1,0,1]
    v_pk_fma_f32 v[72:73], v[180:181], v[136:137], v[72:73] op_sel_hi:[1,0,1]
    v_pk_fma_f32 v[74:75], v[182:183], v[136:137], v[74:75] op_sel_hi:[1,0,1]
    v_pk_fma_f32 v[76:77], v[180:181], v[140:141], v[76:77] op_sel_hi:[1,0,1]
    v_pk_fma_f32 v[78:79], v[182:183], v[140:141], v[78:79] op_sel_hi:[1,0,1]
    v_pk_fma_f32 v[80:81], v[180:181], v[144:145], v[80:81] op_sel_hi:[1,0,1]
    v_pk_fma_f32 v[82:83], v[182:183], v[144:145], v[82:83] op_sel_hi:[1,0,1]
    v_pk_mul_f32 v[160:161], v[64:65], v[128:129] op_sel:[0,1] op_sel_hi:[1,1]
    v_pk_mul_f32 v[162:163], v[68:69], v[132:133] op_sel:[0,1] op_sel_hi:[1,1]
    v_pk_mul_f32 v[164:165], v[72:73], v[136:137] op_sel:[0,1] op_sel_hi:[1,1]
    v_pk_mul_f32 v[166:167], v[76:77], v[140:141] op_sel:[0,1] op_sel_hi:[1,1]
    v_pk_mul_f32 v[168:169], v[80:81], v[144:145] op_sel:[0,1] op_sel_hi:[1,1]
    v_exp_f32 v160, v160
    v_exp_f32 v161, v161
    v_exp_f32 v162, v162
    v_exp_f32 v163, v163
    v_exp_f32 v164, v164
    v_exp_f32 v165, v165
    v_exp_f32 v166, v166
    v_exp_f32 v167, v167
    v_exp_f32 v168, v168
    v_exp_f32 v169, v169
    v_pk_mul_f32 v[64:65], v[64:65], v[66:67]
    v_pk_add_f32 v[160:161], v[160:161], 1.0 op_sel_hi:[1,0]
    v_pk_mul_f32 v[68:69], v[68:69], v[70:71]
    v_pk_add_f32 v[162:163], v[162:163], 1.0 op_sel_hi:[1,0]
    v_pk_mul_f32 v[72:73], v[72:73], v[74:75]
    v_pk_add_f32 v[164:165], v[164:165], 1.0 op_sel_hi:[1,0]
    v_pk_mul_f32 v[76:77], v[76:77], v[78:79]
    v_pk_add_f32 v[166:167], v[166:167], 1.0 op_sel_hi:[1,0]
    v_pk_mul_f32 v[80:81], v[80:81], v[82:83]
    v_pk_add_f32 v[168:169], v[168:169], 1.0 op_sel_hi:[1,0]
    v_rcp_f32 v160, v160
    v_rcp_f32 v161, v161
    v_rcp_f32 v162, v162
    v_rcp_f32 v163, v163
    v_rcp_f32 v164, v164
    v_rcp_f32 v165, v165
    v_rcp_f32 v166, v166
    v_rcp_f32 v167, v167
    v_rcp_f32 v168, v168
    v_rcp_f32 v169, v169
    v_pk_mul_f32 v[64:65], v[64:65], v[130:131] op_sel_hi:[1,0]
    v_pk_mul_f32 v[68:69], v[68:69], v[134:135] op_sel_hi:[1,0]
    v_pk_mul_f32 v[72:73], v[72:73], v[138:139] op_sel_hi:[1,0]
    v_pk_mul_f32 v[76:77], v[76:77], v[142:143] op_sel_hi:[1,0]
    v_pk_mul_f32 v[80:81], v[80:81], v[146:147] op_sel_hi:[1,0]
    v_pk_mul_f32 v[64:65], v[64:65], v[160:161]
    v_pk_mul_f32 v[68:69], v[68:69], v[162:163]
    v_pk_mul_f32 v[72:73], v[72:73], v[164:165]
    v_pk_mul_f32 v[76:77], v[76:77], v[166:167]
    v_pk_mul_f32 v[80:81], v[80:81], v[168:169]
    v_cvt_pk_bf16_f32 v66, v64, v65
    ds_write_b32 v7, v66 offset:0
    v_cvt_pk_bf16_f32 v70, v68, v69
    ds_write_b32 v7, v70 offset:3072
    v_cvt_pk_bf16_f32 v74, v72, v73
    ds_write_b32 v7, v74 offset:6144
    v_cvt_pk_bf16_f32 v78, v76, v77
    ds_write_b32 v7, v78 offset:9216
    v_cvt_pk_bf16_f32 v82, v80, v81
    ds_write_b32 v7, v82 offset:12288
    s_add_u32 s10, s7, 2
    s_lshr_b32 s11, s10, 2
    s_and_b32 s10, s10, 3
    s_lshl_b32 s11, s11, 10
    s_lshl_b32 s10, s10, 2
    s_add_u32 s10, s10, s11
    v_add_u32 v7, s10, v9
    v_pk_fma_f32 v[96:97], v[184:185], v[128:129], v[96:97] op_sel_hi:[1,0,1]
    v_pk_fma_f32 v[98:99], v[186:187], v[128:129], v[98:99] op_sel_hi:[1,0,1]
    v_pk_fma_f32 v[100:101], v[184:185], v[132:133], v[100:101] op_sel_hi:[1,0,1]
    v_pk_fma_f32 v[102:103], v[186:187], v[132:133], v[102:103] op_sel_hi:[1,0,1]
    v_pk_fma_f32 v[104:105], v[184:185], v[136:137], v[104:105] op_sel_hi:[1,0,1]
    v_pk_fma_f32 v[106:107], v[186:187], v[136:137], v[106:107] op_sel_hi:[1,0,1]
    v_pk_fma_f32 v[108:109], v[184:185], v[140:141], v[108:109] op_sel_hi:[1,0,1]
    v_pk_fma_f32 v[110:111], v[186:187], v[140:141], v[110:111] op_sel_hi:[1,0,1]
    v_pk_fma_f32 v[112:113], v[184:185], v[144:145], v[112:113] op_sel_hi:[1,0,1]
    v_pk_fma_f32 v[114:115], v[186:187], v[144:145], v[114:115] op_sel_hi:[1,0,1]
    v_pk_mul_f32 v[160:161], v[96:97], v[128:129] op_sel:[0,1] op_sel_hi:[1,1]
    v_pk_mul_f32 v[162:163], v[100:101], v[132:133] op_sel:[0,1] op_sel_hi:[1,1]
    v_pk_mul_f32 v[164:165], v[104:105], v[136:137] op_sel:[0,1] op_sel_hi:[1,1]
    v_pk_mul_f32 v[166:167], v[108:109], v[140:141] op_sel:[0,1] op_sel_hi:[1,1]
    v_pk_mul_f32 v[168:169], v[112:113], v[144:145] op_sel:[0,1] op_sel_hi:[1,1]
    v_exp_f32 v160, v160
    v_exp_f32 v161, v161
    v_exp_f32 v162, v162
    v_exp_f32 v163, v163
    v_exp_f32 v164, v164
    v_exp_f32 v165, v165
    v_exp_f32 v166, v166
    v_exp_f32 v167, v167
    v_exp_f32 v168, v168
    v_exp_f32 v169, v169
    v_pk_mul_f32 v[96:97], v[96:97], v[98:99]
    v_pk_add_f32 v[160:161], v[160:161], 1.0 op_sel_hi:[1,0]
    v_pk_mul_f32 v[100:101], v[100:101], v[102:103]
    v_pk_add_f32 v[162:163], v[162:163], 1.0 op_sel_hi:[1,0]
    v_pk_mul_f32 v[104:105], v[104:105], v[106:107]
    v_pk_add_f32 v[164:165], v[164:165], 1.0 op_sel_hi:[1,0]
    v_pk_mul_f32 v[108:109], v[108:109], v[110:111]
    v_pk_add_f32 v[166:167], v[166:167], 1.0 op_sel_hi:[1,0]
    v_pk_mul_f32 v[112:113], v[112:113], v[114:115]
    v_pk_add_f32 v[168:169], v[168:169], 1.0 op_sel_hi:[1,0]
    v_rcp_f32 v160, v160
    v_rcp_f32 v161, v161
    v_rcp_f32 v162, v162
    v_rcp_f32 v163, v163
    v_rcp_f32 v164, v164
    v_rcp_f32 v165, v165
    v_rcp_f32 v166, v166
    v_rcp_f32 v167, v167
    v_rcp_f32 v168, v168
    v_rcp_f32 v169, v169
    v_pk_mul_f32 v[96:97], v[96:97], v[130:131] op_sel_hi:[1,0]
    v_pk_mul_f32 v[100:101], v[100:101], v[134:135] op_sel_hi:[1,0]
    v_pk_mul_f32 v[104:105], v[104:105], v[138:139] op_sel_hi:[1,0]
    v_pk_mul_f32 v[108:109], v[108:109], v[142:143] op_sel_hi:[1,0]
    v_pk_mul_f32 v[112:113], v[112:113], v[146:147] op_sel_hi:[1,0]
    v_pk_mul_f32 v[96:97], v[96:97], v[160:161]
    v_pk_mul_f32 v[100:101], v[100:101], v[162:163]
    v_pk_mul_f32 v[104:105], v[104:105], v[164:165]
    v_pk_mul_f32 v[108:109], v[108:109], v[166:167]
    v_pk_mul_f32 v[112:113], v[112:113], v[168:169]
    v_cvt_pk_bf16_f32 v98, v96, v97
    ds_write_b32 v7, v98 offset:0
    v_cvt_pk_bf16_f32 v102, v100, v101
    ds_write_b32 v7, v102 offset:3072
    v_cvt_pk_bf16_f32 v106, v104, v105
    ds_write_b32 v7, v106 offset:6144
    v_cvt_pk_bf16_f32 v110, v108, v109
    ds_write_b32 v7, v110 offset:9216
    v_cvt_pk_bf16_f32 v114, v112, v113
    ds_write_b32 v7, v114 offset:12288
    s_branch L_mg_store
L_mg_helper:
    v_lshrrev_b32 v7, 4, v1
    s_lshl_b32 s6, s5, 2
    v_add_u32 v7, s6, v7
    v_and_b32 v3, 15, v1
    v_lshlrev_b32 v4, 12, v7
    v_lshl_add_u32 v4, v3, 4, v4
    s_lshl_b32 s6, s74, 8
    s_add_u32 s6, s6, s67
    buffer_load_dwordx4 v[192:195], v4, s[24:27], s6 offen sc1
    s_add_u32 s6, s6, 0x10000
    buffer_load_dwordx4 v[196:199], v4, s[24:27], s6 offen sc1
    s_add_u32 s6, s6, 0x10000
    buffer_load_dwordx4 v[200:203], v4, s[24:27], s6 offen sc1
    s_add_u32 s6, s6, 0x10000
    buffer_load_dwordx4 v[204:207], v4, s[24:27], s6 offen sc1
    s_add_u32 s6, s6, 0x10000
    buffer_load_dwordx4 v[208:211], v4, s[24:27], s6 offen sc1
    s_add_u32 s6, s6, 0x10000
    buffer_load_dwordx4 v[212:215], v4, s[24:27], s6 offen sc1
    s_add_u32 s6, s6, 0x10000
    buffer_load_dwordx4 v[216:219], v4, s[24:27], s6 offen sc1
    s_add_u32 s6, s6, 0x10000
    buffer_load_dwordx4 v[220:223], v4, s[24:27], s6 offen sc1
    s_add_u32 s6, s6, 0x10000
    v_mul_u32_u24 v5, 288, v7
    v_lshl_add_u32 v5, v3, 4, v5
    v_add_u32 v5, 33792, v5
    s_mul_i32 s14, s75, 96
    s_mul_i32 s15, s5, 24
    s_add_u32 s14, s14, s15
    s_lshl_b32 s14, s14, 2
    s_add_u32 s14, s14, 8519680
    s_add_u32 s15, s14, 8192
    s_lshl_b32 s10, s74, 7
    s_add_u32 s10, s10, s69
    s_add_u32 s10, s10, 14336
    v_mov_b32 v10, s10
    s_lshl_b32 s16, s64, 4
    s_add_u32 s16, s16, s74
    s_lshl_b32 s16, s16, 11
    s_lshl_b32 s17, s5, 9
    s_add_u32 s16, s16, s17
    s_add_u32 s16, s16, 8650752
    v_lshlrev_b32 v12, 3, v1
    s_add_u32 s17, s17, 70656
    v_add_u32 v13, s17, v12
    s_mul_i32 s31, s5, 3072
    v_add_u32 v14, s31, v9
    s_waitcnt vmcnt(6)
    ds_write_b128 v5, v[192:195] offset:0
    ds_write_b128 v5, v[196:199] offset:4608
    s_waitcnt vmcnt(4)
    ds_write_b128 v5, v[200:203] offset:9216
    ds_write_b128 v5, v[204:207] offset:13824
    s_waitcnt lgkmcnt(0)
    buffer_load_dwordx4 v[192:195], v4, s[24:27], s6 offen sc1
    s_add_u32 s6, s6, 0x10000
    buffer_load_dwordx4 v[196:199], v4, s[24:27], s6 offen sc1
    s_add_u32 s6, s6, 0x10000
    buffer_load_dwordx4 v[200:203], v4, s[24:27], s6 offen sc1
    s_add_u32 s6, s6, 0x10000
    buffer_load_dwordx4 v[204:207], v4, s[24:27], s6 offen sc1
    s_add_u32 s6, s6, 0x10000
    s_barrier
    s_waitcnt vmcnt(6)
    ds_write_b128 v5, v[208:211] offset:18432
    ds_write_b128 v5, v[212:215] offset:23040
    s_waitcnt vmcnt(4)
    ds_write_b128 v5, v[216:219] offset:27648
    ds_write_b128 v5, v[220:223] offset:32256
    s_waitcnt lgkmcnt(0)
    buffer_load_dwordx4 v[208:211], v4, s[24:27], s6 offen sc1
    s_add_u32 s6, s6, 0x10000
    buffer_load_dwordx4 v[212:215], v4, s[24:27], s6 offen sc1
    s_add_u32 s6, s6, 0x10000
    buffer_load_dwordx4 v[216:219], v4, s[24:27], s6 offen sc1
    s_add_u32 s6, s6, 0x10000
    buffer_load_dwordx4 v[220:223], v4, s[24:27], s6 offen sc1
    s_add_u32 s6, s6, 0x10000
    s_barrier
    s_waitcnt vmcnt(6)
    ds_write_b128 v5, v[192:195] offset:0
    ds_write_b128 v5, v[196:199] offset:4608
    s_waitcnt vmcnt(4)
    ds_write_b128 v5, v[200:203] offset:9216
    ds_write_b128 v5, v[204:207] offset:13824
    s_waitcnt lgkmcnt(0)
    buffer_load_dwordx4 v[192:195], v4, s[24:27], s6 offen sc1
    s_add_u32 s6, s6, 0x10000
    buffer_load_dwordx4 v[196:199], v4, s[24:27], s6 offen sc1
    s_add_u32 s6, s6, 0x10000
    buffer_load_dwordx4 v[200:203], v4, s[24:27], s6 offen sc1
    s_add_u32 s6, s6, 0x10000
    buffer_load_dwordx4 v[204:207], v4, s[24:27], s6 offen sc1
    s_add_u32 s6, s6, 0x10000
    s_barrier
    s_waitcnt vmcnt(6)
    ds_write_b128 v5, v[208:211] offset:18432
    ds_write_b128 v5, v[212:215] offset:23040
    s_waitcnt vmcnt(4)
    ds_write_b128 v5, v[216:219] offset:27648
    ds_write_b128 v5, v[220:223] offset:32256
    s_waitcnt lgkmcnt(0)
    buffer_load_dwordx4 v[208:211], v4, s[24:27], s6 offen sc1
    s_add_u32 s6, s6, 0x10000
    buffer_load_dwordx4 v[212:215], v4, s[24:27], s6 offen sc1
    s_add_u32 s6, s6, 0x10000
    buffer_load_dwordx4 v[216:219], v4, s[24:27], s6 offen sc1
    s_add_u32 s6, s6, 0x10000
    buffer_load_dwordx4 v[220:223], v4, s[24:27], s6 offen sc1
    s_add_u32 s6, s6, 0x10000
    s_barrier
    s_waitcnt vmcnt(6)
    ds_write_b128 v5, v[192:195] offset:0
    ds_write_b128 v5, v[196:199] offset:4608
    s_waitcnt vmcnt(4)
    ds_write_b128 v5, v[200:203] offset:9216
    ds_write_b128 v5, v[204:207] offset:13824
    s_waitcnt lgkmcnt(0)
    global_load_dword v11, v10, s[80:81] sc1
    buffer_load_dwordx4 v[192:195], v4, s[24:27], s6 offen sc1
    s_add_u32 s6, s6, 0x10000
    buffer_load_dwordx4 v[196:199], v4, s[24:27], s6 offen sc1
    s_add_u32 s6, s6, 0x10000
    buffer_load_dwordx4 v[200:203], v4, s[24:27], s6 offen sc1
    s_add_u32 s6, s6, 0x10000
    buffer_load_dwordx4 v[204:207], v4, s[24:27], s6 offen sc1
    s_add_u32 s6, s6, 0x10000
    s_barrier
    s_waitcnt vmcnt(7)
    ds_write_b128 v5, v[208:211] offset:18432
    ds_write_b128 v5, v[212:215] offset:23040
    s_waitcnt vmcnt(5)
    ds_write_b128 v5, v[216:219] offset:27648
    ds_write_b128 v5, v[220:223] offset:32256
    s_waitcnt lgkmcnt(0)
    buffer_load_dwordx4 v[208:211], v4, s[24:27], s6 offen sc1
    s_add_u32 s6, s6, 0x10000
    buffer_load_dwordx4 v[212:215], v4, s[24:27], s6 offen sc1
    s_add_u32 s6, s6, 0x10000
    buffer_load_dwordx4 v[216:219], v4, s[24:27], s6 offen sc1
    s_add_u32 s6, s6, 0x10000
    buffer_load_dwordx4 v[220:223], v4, s[24:27], s6 offen sc1
    s_add_u32 s6, s6, 0x10000
    s_barrier
    s_waitcnt vmcnt(6)
    ds_write_b128 v5, v[192:195] offset:0
    ds_write_b128 v5, v[196:199] offset:4608
    s_waitcnt vmcnt(4)
    ds_write_b128 v5, v[200:203] offset:9216
    ds_write_b128 v5, v[204:207] offset:13824
    s_waitcnt lgkmcnt(0)
    s_barrier
    s_mov_b32 s12, 0
L_mg_stp:
    v_readfirstlane_b32 s13, v11
    s_add_u32 s12, s12, 1
    s_cmp_lg_u32 s13, 0
    s_cbranch_scc1 L_mg_stpd
    s_cmp_gt_u32 s12, 0x400000
    s_cbranch_scc1 L_mg_stpd
    global_load_dword v11, v10, s[80:81] sc1
    s_waitcnt vmcnt(0)
    s_branch L_mg_stp
L_mg_stpd:
    buffer_load_dwordx2 v[28:29], v12, s[24:27], s16 offen sc1
    buffer_load_dwordx2 v[16:17], v6, s[24:27], s14 offen offset:0 sc1
    buffer_load_dwordx2 v[18:19], v6, s[24:27], s15 offen offset:0 sc1
    buffer_load_dwordx2 v[20:21], v6, s[24:27], s14 offen offset:32 sc1
    buffer_load_dwordx2 v[22:23], v6, s[24:27], s15 offen offset:32 sc1
    buffer_load_dwordx2 v[24:25], v6, s[24:27], s14 offen offset:64 sc1
    buffer_load_dwordx2 v[26:27], v6, s[24:27], s15 offen offset:64 sc1
    s_waitcnt vmcnt(9)
    ds_write_b128 v5, v[208:211] offset:18432
    ds_write_b128 v5, v[212:215] offset:23040
    s_waitcnt vmcnt(7)
    ds_write_b128 v5, v[216:219] offset:27648
    ds_write_b128 v5, v[220:223] offset:32256
    s_waitcnt lgkmcnt(0)
    s_barrier
    s_waitcnt vmcnt(0)
    ds_write_b128 v14, v[16:19] offset:38912
    ds_write_b128 v14, v[20:23] offset:39936
    ds_write_b128 v14, v[24:27] offset:40960
    ds_write_b64 v13, v[28:29]
    v_and_b32 v30, 63, v0
    v_lshlrev_b32 v30, 4, v30
    s_and_b32 s32, s70, 1
    s_lshl_b32 s32, s32, 11
    v_xor_b32 v30, s32, v30
    v_xor_b32 v31, 2048, v30
    s_and_b32 s33, s75, 7
    s_mul_i32 s33, s33, 43
    s_add_u32 s34, s70, 24
    s_cmp_lt_u32 s70, 4
    s_cselect_b32 s34, s70, s34
    s_add_u32 s33, s33, s34
    s_lshl_b32 s33, s33, 12
    s_add_u32 s33, s33, 16777216
    buffer_load_dwordx4 v[80:83], v30, s[24:27], s33 offen offset:0 sc1
    buffer_load_dwordx4 v[84:87], v30, s[24:27], s33 offen offset:1024 sc1
    buffer_load_dwordx4 v[88:91], v31, s[24:27], s33 offen offset:0 sc1
    buffer_load_dwordx4 v[92:95], v31, s[24:27], s33 offen offset:1024 sc1
    s_add_u32 s33, s33, 16384
    buffer_load_dwordx4 v[96:99], v30, s[24:27], s33 offen offset:0 sc1
    buffer_load_dwordx4 v[100:103], v30, s[24:27], s33 offen offset:1024 sc1
    buffer_load_dwordx4 v[104:107], v31, s[24:27], s33 offen offset:0 sc1
    buffer_load_dwordx4 v[108:111], v31, s[24:27], s33 offen offset:1024 sc1
    s_add_u32 s33, s33, 16384
    buffer_load_dwordx4 v[112:115], v30, s[24:27], s33 offen offset:0 sc1
    buffer_load_dwordx4 v[116:119], v30, s[24:27], s33 offen offset:1024 sc1
    buffer_load_dwordx4 v[120:123], v31, s[24:27], s33 offen offset:0 sc1
    buffer_load_dwordx4 v[124:127], v31, s[24:27], s33 offen offset:1024 sc1
    s_add_u32 s33, s33, 16384
    v_lshlrev_b32 v3, 4, v3
    v_add_u32 v3, 33792, v3
    s_mul_i32 s31, s5, 9216
    v_add_u32 v4, s31, v9
    s_waitcnt lgkmcnt(0)
    s_barrier
    ds_read_b128 v[192:195], v3 offset:38144
    ds_read_b128 v[196:199], v3 offset:38400
    ds_read_b128 v[200:203], v3 offset:38656
    ds_read_b128 v[32:35], v4 offset:51200
    ds_read_b128 v[36:39], v4 offset:52224
    ds_read_b128 v[40:43], v4 offset:53248
    ds_read_b128 v[44:47], v4 offset:54272
    ds_read_b128 v[48:51], v4 offset:55296
    ds_read_b128 v[52:55], v4 offset:56320
    ds_read_b128 v[56:59], v4 offset:57344
    ds_read_b128 v[60:63], v4 offset:58368
    ds_read_b128 v[64:67], v4 offset:59392
    s_waitcnt lgkmcnt(0)
    s_add_u32 s10, s7, 0
    s_lshr_b32 s11, s10, 2
    s_and_b32 s10, s10, 3
    s_lshl_b32 s11, s11, 10
    s_lshl_b32 s10, s10, 2
    s_add_u32 s10, s10, s11
    v_add_u32 v7, s10, v9
    v_pk_fma_f32 v[32:33], v[16:17], v[192:193], v[32:33] op_sel_hi:[1,0,1]
    v_pk_fma_f32 v[34:35], v[18:19], v[192:193], v[34:35] op_sel_hi:[1,0,1]
    v_pk_fma_f32 v[36:37], v[16:17], v[196:197], v[36:37] op_sel_hi:[1,0,1]
    v_pk_fma_f32 v[38:39], v[18:19], v[196:197], v[38:39] op_sel_hi:[1,0,1]
    v_pk_fma_f32 v[40:41], v[16:17], v[200:201], v[40:41] op_sel_hi:[1,0,1]
    v_pk_fma_f32 v[42:43], v[18:19], v[200:201], v[42:43] op_sel_hi:[1,0,1]
    v_pk_mul_f32 v[208:209], v[32:33], v[192:193] op_sel:[0,1] op_sel_hi:[1,1]
    v_pk_mul_f32 v[210:211], v[36:37], v[196:197] op_sel:[0,1] op_sel_hi:[1,1]
    v_pk_mul_f32 v[212:213], v[40:41], v[200:201] op_sel:[0,1] op_sel_hi:[1,1]
    v_exp_f32 v208, v208
    v_exp_f32 v209, v209
    v_exp_f32 v210, v210
    v_exp_f32 v211, v211
    v_exp_f32 v212, v212
    v_exp_f32 v213, v213
    v_pk_mul_f32 v[32:33], v[32:33], v[34:35]
    v_pk_add_f32 v[208:209], v[208:209], 1.0 op_sel_hi:[1,0]
    v_pk_mul_f32 v[36:37], v[36:37], v[38:39]
    v_pk_add_f32 v[210:211], v[210:211], 1.0 op_sel_hi:[1,0]
    v_pk_mul_f32 v[40:41], v[40:41], v[42:43]
    v_pk_add_f32 v[212:213], v[212:213], 1.0 op_sel_hi:[1,0]
    v_rcp_f32 v208, v208
    v_rcp_f32 v209, v209
    v_rcp_f32 v210, v210
    v_rcp_f32 v211, v211
    v_rcp_f32 v212, v212
    v_rcp_f32 v213, v213
    v_pk_mul_f32 v[32:33], v[32:33], v[194:195] op_sel_hi:[1,0]
    v_pk_mul_f32 v[36:37], v[36:37], v[198:199] op_sel_hi:[1,0]
    v_pk_mul_f32 v[40:41], v[40:41], v[202:203] op_sel_hi:[1,0]
    v_pk_mul_f32 v[32:33], v[32:33], v[208:209]
    v_pk_mul_f32 v[36:37], v[36:37], v[210:211]
    v_pk_mul_f32 v[40:41], v[40:41], v[212:213]
    v_cvt_pk_bf16_f32 v34, v32, v33
    ds_write_b32 v7, v34 offset:15360
    v_cvt_pk_bf16_f32 v38, v36, v37
    ds_write_b32 v7, v38 offset:18432
    v_cvt_pk_bf16_f32 v42, v40, v41
    ds_write_b32 v7, v42 offset:21504
    s_add_u32 s10, s7, 1
    s_lshr_b32 s11, s10, 2
    s_and_b32 s10, s10, 3
    s_lshl_b32 s11, s11, 10
    s_lshl_b32 s10, s10, 2
    s_add_u32 s10, s10, s11
    v_add_u32 v7, s10, v9
    v_pk_fma_f32 v[44:45], v[20:21], v[192:193], v[44:45] op_sel_hi:[1,0,1]
    v_pk_fma_f32 v[46:47], v[22:23], v[192:193], v[46:47] op_sel_hi:[1,0,1]
    v_pk_fma_f32 v[48:49], v[20:21], v[196:197], v[48:49] op_sel_hi:[1,0,1]
    v_pk_fma_f32 v[50:51], v[22:23], v[196:197], v[50:51] op_sel_hi:[1,0,1]
    v_pk_fma_f32 v[52:53], v[20:21], v[200:201], v[52:53] op_sel_hi:[1,0,1]
    v_pk_fma_f32 v[54:55], v[22:23], v[200:201], v[54:55] op_sel_hi:[1,0,1]
    v_pk_mul_f32 v[208:209], v[44:45], v[192:193] op_sel:[0,1] op_sel_hi:[1,1]
    v_pk_mul_f32 v[210:211], v[48:49], v[196:197] op_sel:[0,1] op_sel_hi:[1,1]
    v_pk_mul_f32 v[212:213], v[52:53], v[200:201] op_sel:[0,1] op_sel_hi:[1,1]
    v_exp_f32 v208, v208
    v_exp_f32 v209, v209
    v_exp_f32 v210, v210
    v_exp_f32 v211, v211
    v_exp_f32 v212, v212
    v_exp_f32 v213, v213
    v_pk_mul_f32 v[44:45], v[44:45], v[46:47]
    v_pk_add_f32 v[208:209], v[208:209], 1.0 op_sel_hi:[1,0]
    v_pk_mul_f32 v[48:49], v[48:49], v[50:51]
    v_pk_add_f32 v[210:211], v[210:211], 1.0 op_sel_hi:[1,0]
    v_pk_mul_f32 v[52:53], v[52:53], v[54:55]
    v_pk_add_f32 v[212:213], v[212:213], 1.0 op_sel_hi:[1,0]
    v_rcp_f32 v208, v208
    v_rcp_f32 v209, v209
    v_rcp_f32 v210, v210
    v_rcp_f32 v211, v211
    v_rcp_f32 v212, v212
    v_rcp_f32 v213, v213
    v_pk_mul_f32 v[44:45], v[44:45], v[194:195] op_sel_hi:[1,0]
    v_pk_mul_f32 v[48:49], v[48:49], v[198:199] op_sel_hi:[1,0]
    v_pk_mul_f32 v[52:53], v[52:53], v[202:203] op_sel_hi:[1,0]
    v_pk_mul_f32 v[44:45], v[44:45], v[208:209]
    v_pk_mul_f32 v[48:49], v[48:49], v[210:211]
    v_pk_mul_f32 v[52:53], v[52:53], v[212:213]
    v_cvt_pk_bf16_f32 v46, v44, v45
    ds_write_b32 v7, v46 offset:15360
    v_cvt_pk_bf16_f32 v50, v48, v49
    ds_write_b32 v7, v50 offset:18432
    v_cvt_pk_bf16_f32 v54, v52, v53
    ds_write_b32 v7, v54 offset:21504
    s_add_u32 s10, s7, 2
    s_lshr_b32 s11, s10, 2
    s_and_b32 s10, s10, 3
    s_lshl_b32 s11, s11, 10
    s_lshl_b32 s10, s10, 2
    s_add_u32 s10, s10, s11
    v_add_u32 v7, s10, v9
    v_pk_fma_f32 v[56:57], v[24:25], v[192:193], v[56:57] op_sel_hi:[1,0,1]
    v_pk_fma_f32 v[58:59], v[26:27], v[192:193], v[58:59] op_sel_hi:[1,0,1]
    v_pk_fma_f32 v[60:61], v[24:25], v[196:197], v[60:61] op_sel_hi:[1,0,1]
    v_pk_fma_f32 v[62:63], v[26:27], v[196:197], v[62:63] op_sel_hi:[1,0,1]
    v_pk_fma_f32 v[64:65], v[24:25], v[200:201], v[64:65] op_sel_hi:[1,0,1]
    v_pk_fma_f32 v[66:67], v[26:27], v[200:201], v[66:67] op_sel_hi:[1,0,1]
    v_pk_mul_f32 v[208:209], v[56:57], v[192:193] op_sel:[0,1] op_sel_hi:[1,1]
    v_pk_mul_f32 v[210:211], v[60:61], v[196:197] op_sel:[0,1] op_sel_hi:[1,1]
    v_pk_mul_f32 v[212:213], v[64:65], v[200:201] op_sel:[0,1] op_sel_hi:[1,1]
    v_exp_f32 v208, v208
    v_exp_f32 v209, v209
    v_exp_f32 v210, v210
    v_exp_f32 v211, v211
    v_exp_f32 v212, v212
    v_exp_f32 v213, v213
    v_pk_mul_f32 v[56:57], v[56:57], v[58:59]
    v_pk_add_f32 v[208:209], v[208:209], 1.0 op_sel_hi:[1,0]
    v_pk_mul_f32 v[60:61], v[60:61], v[62:63]
    v_pk_add_f32 v[210:211], v[210:211], 1.0 op_sel_hi:[1,0]
    v_pk_mul_f32 v[64:65], v[64:65], v[66:67]
    v_pk_add_f32 v[212:213], v[212:213], 1.0 op_sel_hi:[1,0]
    v_rcp_f32 v208, v208
    v_rcp_f32 v209, v209
    v_rcp_f32 v210, v210
    v_rcp_f32 v211, v211
    v_rcp_f32 v212, v212
    v_rcp_f32 v213, v213
    v_pk_mul_f32 v[56:57], v[56:57], v[194:195] op_sel_hi:[1,0]
    v_pk_mul_f32 v[60:61], v[60:61], v[198:199] op_sel_hi:[1,0]
    v_pk_mul_f32 v[64:65], v[64:65], v[202:203] op_sel_hi:[1,0]
    v_pk_mul_f32 v[56:57], v[56:57], v[208:209]
    v_pk_mul_f32 v[60:61], v[60:61], v[210:211]
    v_pk_mul_f32 v[64:65], v[64:65], v[212:213]
    v_cvt_pk_bf16_f32 v58, v56, v57
    ds_write_b32 v7, v58 offset:15360
    v_cvt_pk_bf16_f32 v62, v60, v61
    ds_write_b32 v7, v62 offset:18432
    v_cvt_pk_bf16_f32 v66, v64, v65
    ds_write_b32 v7, v66 offset:21504
    buffer_load_dwordx4 v[128:131], v30, s[24:27], s33 offen offset:0 sc1
    buffer_load_dwordx4 v[132:135], v30, s[24:27], s33 offen offset:1024 sc1
    buffer_load_dwordx4 v[136:139], v31, s[24:27], s33 offen offset:0 sc1
    buffer_load_dwordx4 v[140:143], v31, s[24:27], s33 offen offset:1024 sc1
    s_add_u32 s33, s33, 16384
    buffer_load_dwordx4 v[144:147], v30, s[24:27], s33 offen offset:0 sc1
    buffer_load_dwordx4 v[148:151], v30, s[24:27], s33 offen offset:1024 sc1
    buffer_load_dwordx4 v[152:155], v31, s[24:27], s33 offen offset:0 sc1
    buffer_load_dwordx4 v[156:159], v31, s[24:27], s33 offen offset:1024 sc1
    s_add_u32 s33, s33, 16384
    buffer_load_dwordx4 v[160:163], v30, s[24:27], s33 offen offset:0 sc1
    buffer_load_dwordx4 v[164:167], v30, s[24:27], s33 offen offset:1024 sc1
    buffer_load_dwordx4 v[168:171], v31, s[24:27], s33 offen offset:0 sc1
    buffer_load_dwordx4 v[172:175], v31, s[24:27], s33 offen offset:1024 sc1
    s_add_u32 s33, s33, 16384
    buffer_load_dwordx4 v[176:179], v30, s[24:27], s33 offen offset:0 sc1
    buffer_load_dwordx4 v[180:183], v30, s[24:27], s33 offen offset:1024 sc1
    buffer_load_dwordx4 v[184:187], v31, s[24:27], s33 offen offset:0 sc1
    buffer_load_dwordx4 v[188:191], v31, s[24:27], s33 offen offset:1024 sc1
    s_add_u32 s33, s33, 16384
L_mg_store:
    s_waitcnt lgkmcnt(0)
    s_barrier
    s_mul_i32 s10, s70, 3072
    v_add_u32 v7, s10, v9
    ds_read_b128 v[32:35], v7 offset:0
    ds_read_b128 v[36:39], v7 offset:1024
    ds_read_b128 v[40:43], v7 offset:2048
    s_lshr_b32 s10, s70, 2
    s_mul_i32 s10, s10, 43
    s_add_u32 s10, s10, s9
    s_add_u32 s10, s10, s8
    s_lshl_b32 s10, s10, 12
    s_and_b32 s11, s70, 3
    s_lshl_b32 s11, s11, 10
    s_add_u32 s10, s10, s11
    s_add_u32 s10, s10, s68
    s_waitcnt lgkmcnt(2)
    buffer_store_dwordx4 v[32:35], v2, s[24:27], s10 offen sc1
    s_waitcnt lgkmcnt(0)
    s_cmp_eq_u32 s75, 14
    s_cbranch_scc1 L_mg_done
    s_add_u32 s10, s10, 4096
    buffer_store_dwordx4 v[36:39], v2, s[24:27], s10 offen sc1
    s_add_u32 s10, s10, 4096
    buffer_store_dwordx4 v[40:43], v2, s[24:27], s10 offen sc1
    s_branch L_mg_done
L_mg_idle:
    v_and_b32 v1, 63, v0
    v_lshrrev_b32 v7, 4, v0
    v_and_b32 v3, 15, v1
    v_lshlrev_b32 v4, 12, v7
    v_lshl_add_u32 v4, v3, 4, v4
    s_lshl_b32 s6, s74, 8
    s_add_u32 s6, s6, s67
    buffer_load_dwordx4 v[64:67], v4, s[24:27], s6 offen sc1
    s_add_u32 s6, s6, 0x20000
    buffer_load_dwordx4 v[68:71], v4, s[24:27], s6 offen sc1
    s_add_u32 s6, s6, 0x20000
    buffer_load_dwordx4 v[72:75], v4, s[24:27], s6 offen sc1
    s_add_u32 s6, s6, 0x20000
    buffer_load_dwordx4 v[76:79], v4, s[24:27], s6 offen sc1
    s_add_u32 s6, s6, 0x20000
    buffer_load_dwordx4 v[80:83], v4, s[24:27], s6 offen sc1
    s_add_u32 s6, s6, 0x20000
    buffer_load_dwordx4 v[84:87], v4, s[24:27], s6 offen sc1
    s_add_u32 s6, s6, 0x20000
    buffer_load_dwordx4 v[88:91], v4, s[24:27], s6 offen sc1
    s_add_u32 s6, s6, 0x20000
    buffer_load_dwordx4 v[92:95], v4, s[24:27], s6 offen sc1
    s_add_u32 s6, s6, 0x20000
    buffer_load_dwordx4 v[96:99], v4, s[24:27], s6 offen sc1
    s_add_u32 s6, s6, 0x20000
    buffer_load_dwordx4 v[100:103], v4, s[24:27], s6 offen sc1
    s_add_u32 s6, s6, 0x20000
    buffer_load_dwordx4 v[104:107], v4, s[24:27], s6 offen sc1
    s_add_u32 s6, s6, 0x20000
    buffer_load_dwordx4 v[108:111], v4, s[24:27], s6 offen sc1
    s_add_u32 s6, s6, 0x20000
    buffer_load_dwordx4 v[112:115], v4, s[24:27], s6 offen sc1
    s_add_u32 s6, s6, 0x20000
    buffer_load_dwordx4 v[116:119], v4, s[24:27], s6 offen sc1
    s_add_u32 s6, s6, 0x20000
    buffer_load_dwordx4 v[120:123], v4, s[24:27], s6 offen sc1
    s_add_u32 s6, s6, 0x20000
    buffer_load_dwordx4 v[124:127], v4, s[24:27], s6 offen sc1
    s_add_u32 s6, s6, 0x20000
    v_mov_b32 v16, 0
    v_mov_b32 v17, 0
    v_mov_b32 v18, 0
    v_mov_b32 v19, 0
    v_mov_b32 v20, 0
    v_mov_b32 v21, 0
    v_mov_b32 v22, 0
    v_mov_b32 v23, 0
    v_mov_b32 v24, 0
    v_mov_b32 v25, 0
    v_mov_b32 v26, 0
    v_mov_b32 v27, 0
    v_mov_b32 v28, 0
    v_mov_b32 v29, 0
    v_mov_b32 v30, 0
    v_mov_b32 v31, 0
    s_waitcnt vmcnt(15)
    v_lshlrev_b32 v32, 16, v64
    v_and_b32 v33, 0xffff0000, v64
    v_lshlrev_b32 v34, 16, v65
    v_and_b32 v35, 0xffff0000, v65
    v_lshlrev_b32 v36, 16, v66
    v_and_b32 v37, 0xffff0000, v66
    v_lshlrev_b32 v38, 16, v67
    v_and_b32 v39, 0xffff0000, v67
    v_pk_add_f32 v[16:17], v[16:17], v[32:33]
    v_pk_fma_f32 v[24:25], v[32:33], v[32:33], v[24:25]
    v_pk_add_f32 v[18:19], v[18:19], v[34:35]
    v_pk_fma_f32 v[26:27], v[34:35], v[34:35], v[26:27]
    v_pk_add_f32 v[20:21], v[20:21], v[36:37]
    v_pk_fma_f32 v[28:29], v[36:37], v[36:37], v[28:29]
    v_pk_add_f32 v[22:23], v[22:23], v[38:39]
    v_pk_fma_f32 v[30:31], v[38:39], v[38:39], v[30:31]
    s_waitcnt vmcnt(14)
    v_lshlrev_b32 v32, 16, v68
    v_and_b32 v33, 0xffff0000, v68
    v_lshlrev_b32 v34, 16, v69
    v_and_b32 v35, 0xffff0000, v69
    v_lshlrev_b32 v36, 16, v70
    v_and_b32 v37, 0xffff0000, v70
    v_lshlrev_b32 v38, 16, v71
    v_and_b32 v39, 0xffff0000, v71
    v_pk_add_f32 v[16:17], v[16:17], v[32:33]
    v_pk_fma_f32 v[24:25], v[32:33], v[32:33], v[24:25]
    v_pk_add_f32 v[18:19], v[18:19], v[34:35]
    v_pk_fma_f32 v[26:27], v[34:35], v[34:35], v[26:27]
    v_pk_add_f32 v[20:21], v[20:21], v[36:37]
    v_pk_fma_f32 v[28:29], v[36:37], v[36:37], v[28:29]
    v_pk_add_f32 v[22:23], v[22:23], v[38:39]
    v_pk_fma_f32 v[30:31], v[38:39], v[38:39], v[30:31]
    s_waitcnt vmcnt(13)
    v_lshlrev_b32 v32, 16, v72
    v_and_b32 v33, 0xffff0000, v72
    v_lshlrev_b32 v34, 16, v73
    v_and_b32 v35, 0xffff0000, v73
    v_lshlrev_b32 v36, 16, v74
    v_and_b32 v37, 0xffff0000, v74
    v_lshlrev_b32 v38, 16, v75
    v_and_b32 v39, 0xffff0000, v75
    v_pk_add_f32 v[16:17], v[16:17], v[32:33]
    v_pk_fma_f32 v[24:25], v[32:33], v[32:33], v[24:25]
    v_pk_add_f32 v[18:19], v[18:19], v[34:35]
    v_pk_fma_f32 v[26:27], v[34:35], v[34:35], v[26:27]
    v_pk_add_f32 v[20:21], v[20:21], v[36:37]
    v_pk_fma_f32 v[28:29], v[36:37], v[36:37], v[28:29]
    v_pk_add_f32 v[22:23], v[22:23], v[38:39]
    v_pk_fma_f32 v[30:31], v[38:39], v[38:39], v[30:31]
    s_waitcnt vmcnt(12)
    v_lshlrev_b32 v32, 16, v76
    v_and_b32 v33, 0xffff0000, v76
    v_lshlrev_b32 v34, 16, v77
    v_and_b32 v35, 0xffff0000, v77
    v_lshlrev_b32 v36, 16, v78
    v_and_b32 v37, 0xffff0000, v78
    v_lshlrev_b32 v38, 16, v79
    v_and_b32 v39, 0xffff0000, v79
    v_pk_add_f32 v[16:17], v[16:17], v[32:33]
    v_pk_fma_f32 v[24:25], v[32:33], v[32:33], v[24:25]
    v_pk_add_f32 v[18:19], v[18:19], v[34:35]
    v_pk_fma_f32 v[26:27], v[34:35], v[34:35], v[26:27]
    v_pk_add_f32 v[20:21], v[20:21], v[36:37]
    v_pk_fma_f32 v[28:29], v[36:37], v[36:37], v[28:29]
    v_pk_add_f32 v[22:23], v[22:23], v[38:39]
    v_pk_fma_f32 v[30:31], v[38:39], v[38:39], v[30:31]
    s_waitcnt vmcnt(11)
    v_lshlrev_b32 v32, 16, v80
    v_and_b32 v33, 0xffff0000, v80
    v_lshlrev_b32 v34, 16, v81
    v_and_b32 v35, 0xffff0000, v81
    v_lshlrev_b32 v36, 16, v82
    v_and_b32 v37, 0xffff0000, v82
    v_lshlrev_b32 v38, 16, v83
    v_and_b32 v39, 0xffff0000, v83
    v_pk_add_f32 v[16:17], v[16:17], v[32:33]
    v_pk_fma_f32 v[24:25], v[32:33], v[32:33], v[24:25]
    v_pk_add_f32 v[18:19], v[18:19], v[34:35]
    v_pk_fma_f32 v[26:27], v[34:35], v[34:35], v[26:27]
    v_pk_add_f32 v[20:21], v[20:21], v[36:37]
    v_pk_fma_f32 v[28:29], v[36:37], v[36:37], v[28:29]
    v_pk_add_f32 v[22:23], v[22:23], v[38:39]
    v_pk_fma_f32 v[30:31], v[38:39], v[38:39], v[30:31]
    s_waitcnt vmcnt(10)
    v_lshlrev_b32 v32, 16, v84
    v_and_b32 v33, 0xffff0000, v84
    v_lshlrev_b32 v34, 16, v85
    v_and_b32 v35, 0xffff0000, v85
    v_lshlrev_b32 v36, 16, v86
    v_and_b32 v37, 0xffff0000, v86
    v_lshlrev_b32 v38, 16, v87
    v_and_b32 v39, 0xffff0000, v87
    v_pk_add_f32 v[16:17], v[16:17], v[32:33]
    v_pk_fma_f32 v[24:25], v[32:33], v[32:33], v[24:25]
    v_pk_add_f32 v[18:19], v[18:19], v[34:35]
    v_pk_fma_f32 v[26:27], v[34:35], v[34:35], v[26:27]
    v_pk_add_f32 v[20:21], v[20:21], v[36:37]
    v_pk_fma_f32 v[28:29], v[36:37], v[36:37], v[28:29]
    v_pk_add_f32 v[22:23], v[22:23], v[38:39]
    v_pk_fma_f32 v[30:31], v[38:39], v[38:39], v[30:31]
    s_waitcnt vmcnt(9)
    v_lshlrev_b32 v32, 16, v88
    v_and_b32 v33, 0xffff0000, v88
    v_lshlrev_b32 v34, 16, v89
    v_and_b32 v35, 0xffff0000, v89
    v_lshlrev_b32 v36, 16, v90
    v_and_b32 v37, 0xffff0000, v90
    v_lshlrev_b32 v38, 16, v91
    v_and_b32 v39, 0xffff0000, v91
    v_pk_add_f32 v[16:17], v[16:17], v[32:33]
    v_pk_fma_f32 v[24:25], v[32:33], v[32:33], v[24:25]
    v_pk_add_f32 v[18:19], v[18:19], v[34:35]
    v_pk_fma_f32 v[26:27], v[34:35], v[34:35], v[26:27]
    v_pk_add_f32 v[20:21], v[20:21], v[36:37]
    v_pk_fma_f32 v[28:29], v[36:37], v[36:37], v[28:29]
    v_pk_add_f32 v[22:23], v[22:23], v[38:39]
    v_pk_fma_f32 v[30:31], v[38:39], v[38:39], v[30:31]
    s_waitcnt vmcnt(8)
    v_lshlrev_b32 v32, 16, v92
    v_and_b32 v33, 0xffff0000, v92
    v_lshlrev_b32 v34, 16, v93
    v_and_b32 v35, 0xffff0000, v93
    v_lshlrev_b32 v36, 16, v94
    v_and_b32 v37, 0xffff0000, v94
    v_lshlrev_b32 v38, 16, v95
    v_and_b32 v39, 0xffff0000, v95
    v_pk_add_f32 v[16:17], v[16:17], v[32:33]
    v_pk_fma_f32 v[24:25], v[32:33], v[32:33], v[24:25]
    v_pk_add_f32 v[18:19], v[18:19], v[34:35]
    v_pk_fma_f32 v[26:27], v[34:35], v[34:35], v[26:27]
    v_pk_add_f32 v[20:21], v[20:21], v[36:37]
    v_pk_fma_f32 v[28:29], v[36:37], v[36:37], v[28:29]
    v_pk_add_f32 v[22:23], v[22:23], v[38:39]
    v_pk_fma_f32 v[30:31], v[38:39], v[38:39], v[30:31]
    s_waitcnt vmcnt(7)
    v_lshlrev_b32 v32, 16, v96
    v_and_b32 v33, 0xffff0000, v96
    v_lshlrev_b32 v34, 16, v97
    v_and_b32 v35, 0xffff0000, v97
    v_lshlrev_b32 v36, 16, v98
    v_and_b32 v37, 0xffff0000, v98
    v_lshlrev_b32 v38, 16, v99
    v_and_b32 v39, 0xffff0000, v99
    v_pk_add_f32 v[16:17], v[16:17], v[32:33]
    v_pk_fma_f32 v[24:25], v[32:33], v[32:33], v[24:25]
    v_pk_add_f32 v[18:19], v[18:19], v[34:35]
    v_pk_fma_f32 v[26:27], v[34:35], v[34:35], v[26:27]
    v_pk_add_f32 v[20:21], v[20:21], v[36:37]
    v_pk_fma_f32 v[28:29], v[36:37], v[36:37], v[28:29]
    v_pk_add_f32 v[22:23], v[22:23], v[38:39]
    v_pk_fma_f32 v[30:31], v[38:39], v[38:39], v[30:31]
    s_waitcnt vmcnt(6)
    v_lshlrev_b32 v32, 16, v100
    v_and_b32 v33, 0xffff0000, v100
    v_lshlrev_b32 v34, 16, v101
    v_and_b32 v35, 0xffff0000, v101
    v_lshlrev_b32 v36, 16, v102
    v_and_b32 v37, 0xffff0000, v102
    v_lshlrev_b32 v38, 16, v103
    v_and_b32 v39, 0xffff0000, v103
    v_pk_add_f32 v[16:17], v[16:17], v[32:33]
    v_pk_fma_f32 v[24:25], v[32:33], v[32:33], v[24:25]
    v_pk_add_f32 v[18:19], v[18:19], v[34:35]
    v_pk_fma_f32 v[26:27], v[34:35], v[34:35], v[26:27]
    v_pk_add_f32 v[20:21], v[20:21], v[36:37]
    v_pk_fma_f32 v[28:29], v[36:37], v[36:37], v[28:29]
    v_pk_add_f32 v[22:23], v[22:23], v[38:39]
    v_pk_fma_f32 v[30:31], v[38:39], v[38:39], v[30:31]
    s_waitcnt vmcnt(5)
    v_lshlrev_b32 v32, 16, v104
    v_and_b32 v33, 0xffff0000, v104
    v_lshlrev_b32 v34, 16, v105
    v_and_b32 v35, 0xffff0000, v105
    v_lshlrev_b32 v36, 16, v106
    v_and_b32 v37, 0xffff0000, v106
    v_lshlrev_b32 v38, 16, v107
    v_and_b32 v39, 0xffff0000, v107
    v_pk_add_f32 v[16:17], v[16:17], v[32:33]
    v_pk_fma_f32 v[24:25], v[32:33], v[32:33], v[24:25]
    v_pk_add_f32 v[18:19], v[18:19], v[34:35]
    v_pk_fma_f32 v[26:27], v[34:35], v[34:35], v[26:27]
    v_pk_add_f32 v[20:21], v[20:21], v[36:37]
    v_pk_fma_f32 v[28:29], v[36:37], v[36:37], v[28:29]
    v_pk_add_f32 v[22:23], v[22:23], v[38:39]
    v_pk_fma_f32 v[30:31], v[38:39], v[38:39], v[30:31]
    s_waitcnt vmcnt(4)
    v_lshlrev_b32 v32, 16, v108
    v_and_b32 v33, 0xffff0000, v108
    v_lshlrev_b32 v34, 16, v109
    v_and_b32 v35, 0xffff0000, v109
    v_lshlrev_b32 v36, 16, v110
    v_and_b32 v37, 0xffff0000, v110
    v_lshlrev_b32 v38, 16, v111
    v_and_b32 v39, 0xffff0000, v111
    v_pk_add_f32 v[16:17], v[16:17], v[32:33]
    v_pk_fma_f32 v[24:25], v[32:33], v[32:33], v[24:25]
    v_pk_add_f32 v[18:19], v[18:19], v[34:35]
    v_pk_fma_f32 v[26:27], v[34:35], v[34:35], v[26:27]
    v_pk_add_f32 v[20:21], v[20:21], v[36:37]
    v_pk_fma_f32 v[28:29], v[36:37], v[36:37], v[28:29]
    v_pk_add_f32 v[22:23], v[22:23], v[38:39]
    v_pk_fma_f32 v[30:31], v[38:39], v[38:39], v[30:31]
    s_waitcnt vmcnt(3)
    v_lshlrev_b32 v32, 16, v112
    v_and_b32 v33, 0xffff0000, v112
    v_lshlrev_b32 v34, 16, v113
    v_and_b32 v35, 0xffff0000, v113
    v_lshlrev_b32 v36, 16, v114
    v_and_b32 v37, 0xffff0000, v114
    v_lshlrev_b32 v38, 16, v115
    v_and_b32 v39, 0xffff0000, v115
    v_pk_add_f32 v[16:17], v[16:17], v[32:33]
    v_pk_fma_f32 v[24:25], v[32:33], v[32:33], v[24:25]
    v_pk_add_f32 v[18:19], v[18:19], v[34:35]
    v_pk_fma_f32 v[26:27], v[34:35], v[34:35], v[26:27]
    v_pk_add_f32 v[20:21], v[20:21], v[36:37]
    v_pk_fma_f32 v[28:29], v[36:37], v[36:37], v[28:29]
    v_pk_add_f32 v[22:23], v[22:23], v[38:39]
    v_pk_fma_f32 v[30:31], v[38:39], v[38:39], v[30:31]
    s_waitcnt vmcnt(2)
    v_lshlrev_b32 v32, 16, v116
    v_and_b32 v33, 0xffff0000, v116
    v_lshlrev_b32 v34, 16, v117
    v_and_b32 v35, 0xffff0000, v117
    v_lshlrev_b32 v36, 16, v118
    v_and_b32 v37, 0xffff0000, v118
    v_lshlrev_b32 v38, 16, v119
    v_and_b32 v39, 0xffff0000, v119
    v_pk_add_f32 v[16:17], v[16:17], v[32:33]
    v_pk_fma_f32 v[24:25], v[32:33], v[32:33], v[24:25]
    v_pk_add_f32 v[18:19], v[18:19], v[34:35]
    v_pk_fma_f32 v[26:27], v[34:35], v[34:35], v[26:27]
    v_pk_add_f32 v[20:21], v[20:21], v[36:37]
    v_pk_fma_f32 v[28:29], v[36:37], v[36:37], v[28:29]
    v_pk_add_f32 v[22:23], v[22:23], v[38:39]
    v_pk_fma_f32 v[30:31], v[38:39], v[38:39], v[30:31]
    s_waitcnt vmcnt(1)
    v_lshlrev_b32 v32, 16, v120
    v_and_b32 v33, 0xffff0000, v120
    v_lshlrev_b32 v34, 16, v121
    v_and_b32 v35, 0xffff0000, v121
    v_lshlrev_b32 v36, 16, v122
    v_and_b32 v37, 0xffff0000, v122
    v_lshlrev_b32 v38, 16, v123
    v_and_b32 v39, 0xffff0000, v123
    v_pk_add_f32 v[16:17], v[16:17], v[32:33]
    v_pk_fma_f32 v[24:25], v[32:33], v[32:33], v[24:25]
    v_pk_add_f32 v[18:19], v[18:19], v[34:35]
    v_pk_fma_f32 v[26:27], v[34:35], v[34:35], v[26:27]
    v_pk_add_f32 v[20:21], v[20:21], v[36:37]
    v_pk_fma_f32 v[28:29], v[36:37], v[36:37], v[28:29]
    v_pk_add_f32 v[22:23], v[22:23], v[38:39]
    v_pk_fma_f32 v[30:31], v[38:39], v[38:39], v[30:31]
    s_waitcnt vmcnt(0)
    v_lshlrev_b32 v32, 16, v124
    v_and_b32 v33, 0xffff0000, v124
    v_lshlrev_b32 v34, 16, v125
    v_and_b32 v35, 0xffff0000, v125
    v_lshlrev_b32 v36, 16, v126
    v_and_b32 v37, 0xffff0000, v126
    v_lshlrev_b32 v38, 16, v127
    v_and_b32 v39, 0xffff0000, v127
    v_pk_add_f32 v[16:17], v[16:17], v[32:33]
    v_pk_fma_f32 v[24:25], v[32:33], v[32:33], v[24:25]
    v_pk_add_f32 v[18:19], v[18:19], v[34:35]
    v_pk_fma_f32 v[26:27], v[34:35], v[34:35], v[26:27]
    v_pk_add_f32 v[20:21], v[20:21], v[36:37]
    v_pk_fma_f32 v[28:29], v[36:37], v[36:37], v[28:29]
    v_pk_add_f32 v[22:23], v[22:23], v[38:39]
    v_pk_fma_f32 v[30:31], v[38:39], v[38:39], v[30:31]
    v_permlane32_swap_b32 v16, v24
    v_permlane32_swap_b32 v17, v25
    v_permlane32_swap_b32 v18, v26
    v_permlane32_swap_b32 v19, v27
    v_permlane32_swap_b32 v20, v28
    v_permlane32_swap_b32 v21, v29
    v_permlane32_swap_b32 v22, v30
    v_permlane32_swap_b32 v23, v31
    v_add_f32 v16, v16, v24
    v_add_f32 v17, v17, v25
    v_add_f32 v18, v18, v26
    v_add_f32 v19, v19, v27
    v_add_f32 v20, v20, v28
    v_add_f32 v21, v21, v29
    v_add_f32 v22, v22, v30
    v_add_f32 v23, v23, v31
    v_permlane16_swap_b32 v16, v20
    v_permlane16_swap_b32 v17, v21
    v_permlane16_swap_b32 v18, v22
    v_permlane16_swap_b32 v19, v23
    v_add_f32 v16, v16, v20
    v_add_f32 v17, v17, v21
    v_add_f32 v18, v18, v22
    v_add_f32 v19, v19, v23
    v_lshrrev_b32 v5, 5, v1
    v_lshlrev_b32 v5, 9, v5
    v_lshl_add_u32 v5, v3, 5, v5
    v_bfe_u32 v6, v1, 4, 1
    v_lshl_add_u32 v5, v6, 4, v5
    s_lshl_b32 s6, s70, 10
    s_add_u32 s6, s6, 33792
    v_add_u32 v5, s6, v5
    ds_write_b128 v5, v[16:19]
    v_and_b32 v6, 127, v0
    v_lshlrev_b32 v7, 2, v6
    v_add_u32 v7, 33792, v7
    s_waitcnt lgkmcnt(0)
    s_barrier
    ds_read_b32 v32, v7 offset:0
    ds_read_b32 v33, v7 offset:1024
    ds_read_b32 v34, v7 offset:2048
    ds_read_b32 v35, v7 offset:3072
    ds_read_b32 v36, v7 offset:4096
    ds_read_b32 v37, v7 offset:5120
    ds_read_b32 v38, v7 offset:6144
    ds_read_b32 v39, v7 offset:7168
    s_waitcnt lgkmcnt(1)
    ds_read_b32 v40, v7 offset:512
    ds_read_b32 v41, v7 offset:1536
    ds_read_b32 v42, v7 offset:2560
    ds_read_b32 v43, v7 offset:3584
    ds_read_b32 v44, v7 offset:4608
    ds_read_b32 v45, v7 offset:5632
    ds_read_b32 v46, v7 offset:6656
    ds_read_b32 v47, v7 offset:7680
    s_mov_b32 s28, 0x3b000000
    s_mov_b32 s29, 0x3727c5ac
    s_mov_b32 s30, 0xbfb8aa3b
    s_lshl_b32 s10, s64, 4
    s_add_u32 s10, s10, s74
    s_lshl_b32 s10, s10, 11
    s_add_u32 s10, s10, 8650752
    v_lshlrev_b32 v6, 4, v6
    s_waitcnt lgkmcnt(0)
    v_add_f32 v32, v32, v33
    v_add_f32 v40, v40, v41
    v_add_f32 v32, v32, v34
    v_add_f32 v40, v40, v42
    v_add_f32 v32, v32, v35
    v_add_f32 v40, v40, v43
    v_add_f32 v32, v32, v36
    v_add_f32 v40, v40, v44
    v_add_f32 v32, v32, v37
    v_add_f32 v40, v40, v45
    v_add_f32 v32, v32, v38
    v_add_f32 v40, v40, v46
    v_add_f32 v32, v32, v39
    v_add_f32 v40, v40, v47
    v_mul_f32 v32, s28, v32
    v_mul_f32 v40, s28, v40
    v_fma_f32 v40, -v32, v32, v40
    v_max_f32 v40, 0, v40
    v_add_f32 v40, s29, v40
    v_rsq_f32 v40, v40
    v_sub_f32 v44, 0, v32
    v_mov_b32 v47, 0
    v_mul_f32 v45, s30, v40
    v_mul_f32 v46, v40, v40
    s_cmp_ge_u32 s70, 2
    s_cbranch_scc1 L_mg_st2
    buffer_store_dwordx4 v[44:47], v6, s[24:27], s10 offen sc1
L_mg_st2:
    s_waitcnt vmcnt(0)
    s_barrier
    s_cmp_lg_u32 s70, 0
    s_cbranch_scc1 L_mg_st3
    s_lshl_b32 s10, s74, 7
    s_add_u32 s10, s10, s69
    s_add_u32 s10, s10, 14336
    v_mov_b32 v10, s10
    v_mov_b32 v11, 1
    s_mov_b64 exec, 1
    global_store_dword v10, v11, s[80:81] sc1
    s_mov_b64 exec, -1
L_mg_st3:
    s_cmp_ge_u32 s70, 4
    s_cbranch_scc1 L_mg_done
    v_and_b32 v10, 63, v0
    v_lshlrev_b32 v10, 4, v10
    s_and_b32 s32, s70, 1
    s_lshl_b32 s32, s32, 11
    v_xor_b32 v10, s32, v10
    v_xor_b32 v11, 2048, v10
    s_and_b32 s33, s75, 7
    s_mul_i32 s33, s33, 43
    s_add_u32 s34, s70, 24
    s_cmp_lt_u32 s70, 4
    s_cselect_b32 s34, s70, s34
    s_add_u32 s33, s33, s34
    s_lshl_b32 s33, s33, 12
    s_add_u32 s33, s33, 16777216
    buffer_load_dwordx4 v[80:83], v10, s[24:27], s33 offen offset:0 sc1
    buffer_load_dwordx4 v[84:87], v10, s[24:27], s33 offen offset:1024 sc1
    buffer_load_dwordx4 v[88:91], v11, s[24:27], s33 offen offset:0 sc1
    buffer_load_dwordx4 v[92:95], v11, s[24:27], s33 offen offset:1024 sc1
    s_add_u32 s33, s33, 16384
    buffer_load_dwordx4 v[96:99], v10, s[24:27], s33 offen offset:0 sc1
    buffer_load_dwordx4 v[100:103], v10, s[24:27], s33 offen offset:1024 sc1
    buffer_load_dwordx4 v[104:107], v11, s[24:27], s33 offen offset:0 sc1
    buffer_load_dwordx4 v[108:111], v11, s[24:27], s33 offen offset:1024 sc1
    s_add_u32 s33, s33, 16384
    buffer_load_dwordx4 v[112:115], v10, s[24:27], s33 offen offset:0 sc1
    buffer_load_dwordx4 v[116:119], v10, s[24:27], s33 offen offset:1024 sc1
    buffer_load_dwordx4 v[120:123], v11, s[24:27], s33 offen offset:0 sc1
    buffer_load_dwordx4 v[124:127], v11, s[24:27], s33 offen offset:1024 sc1
    s_add_u32 s33, s33, 16384
    buffer_load_dwordx4 v[128:131], v10, s[24:27], s33 offen offset:0 sc1
    buffer_load_dwordx4 v[132:135], v10, s[24:27], s33 offen offset:1024 sc1
    buffer_load_dwordx4 v[136:139], v11, s[24:27], s33 offen offset:0 sc1
    buffer_load_dwordx4 v[140:143], v11, s[24:27], s33 offen offset:1024 sc1
    s_add_u32 s33, s33, 16384
    buffer_load_dwordx4 v[144:147], v10, s[24:27], s33 offen offset:0 sc1
    buffer_load_dwordx4 v[148:151], v10, s[24:27], s33 offen offset:1024 sc1
    buffer_load_dwordx4 v[152:155], v11, s[24:27], s33 offen offset:0 sc1
    buffer_load_dwordx4 v[156:159], v11, s[24:27], s33 offen offset:1024 sc1
    s_add_u32 s33, s33, 16384
    buffer_load_dwordx4 v[160:163], v10, s[24:27], s33 offen offset:0 sc1
    buffer_load_dwordx4 v[164:167], v10, s[24:27], s33 offen offset:1024 sc1
    buffer_load_dwordx4 v[168:171], v11, s[24:27], s33 offen offset:0 sc1
    buffer_load_dwordx4 v[172:175], v11, s[24:27], s33 offen offset:1024 sc1
    s_add_u32 s33, s33, 16384
    buffer_load_dwordx4 v[176:179], v10, s[24:27], s33 offen offset:0 sc1
    buffer_load_dwordx4 v[180:183], v10, s[24:27], s33 offen offset:1024 sc1
    buffer_load_dwordx4 v[184:187], v11, s[24:27], s33 offen offset:0 sc1
    buffer_load_dwordx4 v[188:191], v11, s[24:27], s33 offen offset:1024 sc1
    s_add_u32 s33, s33, 16384
L_mg_done:
    s_waitcnt vmcnt(0)
    s_barrier
    s_cmp_lg_u32 s70, 0
    s_cbranch_scc1 L_b2_nosig
    s_add_u32 s11, s69, 6144
    v_mov_b32 v4, 1
    s_lshl_b32 s10, s74, 7
    s_add_u32 s10, s10, s11
    v_mov_b32 v7, s10
    s_mov_b64 exec, 1
    global_atomic_add v7, v4, s[80:81] sc1
    s_mov_b64 exec, -1
L_b2_nosig:
    s_cmp_lt_u32 s70, 4
    s_cbranch_scc1 L_dnp_skip
    v_and_b32 v10, 63, v0
    v_lshlrev_b32 v10, 4, v10
    s_and_b32 s32, s70, 1
    s_lshl_b32 s32, s32, 11
    v_xor_b32 v10, s32, v10
    v_xor_b32 v11, 2048, v10
    s_and_b32 s33, s75, 7
    s_mul_i32 s33, s33, 43
    s_add_u32 s34, s70, 24
    s_cmp_lt_u32 s70, 4
    s_cselect_b32 s34, s70, s34
    s_add_u32 s33, s33, s34
    s_lshl_b32 s33, s33, 12
    s_add_u32 s33, s33, 16777216
    buffer_load_dwordx4 v[80:83], v10, s[24:27], s33 offen offset:0 sc1
    buffer_load_dwordx4 v[84:87], v10, s[24:27], s33 offen offset:1024 sc1
    buffer_load_dwordx4 v[88:91], v11, s[24:27], s33 offen offset:0 sc1
    buffer_load_dwordx4 v[92:95], v11, s[24:27], s33 offen offset:1024 sc1
    s_add_u32 s33, s33, 16384
    buffer_load_dwordx4 v[96:99], v10, s[24:27], s33 offen offset:0 sc1
    buffer_load_dwordx4 v[100:103], v10, s[24:27], s33 offen offset:1024 sc1
    buffer_load_dwordx4 v[104:107], v11, s[24:27], s33 offen offset:0 sc1
    buffer_load_dwordx4 v[108:111], v11, s[24:27], s33 offen offset:1024 sc1
    s_add_u32 s33, s33, 16384
    buffer_load_dwordx4 v[112:115], v10, s[24:27], s33 offen offset:0 sc1
    buffer_load_dwordx4 v[116:119], v10, s[24:27], s33 offen offset:1024 sc1
    buffer_load_dwordx4 v[120:123], v11, s[24:27], s33 offen offset:0 sc1
    buffer_load_dwordx4 v[124:127], v11, s[24:27], s33 offen offset:1024 sc1
    s_add_u32 s33, s33, 16384
    buffer_load_dwordx4 v[128:131], v10, s[24:27], s33 offen offset:0 sc1
    buffer_load_dwordx4 v[132:135], v10, s[24:27], s33 offen offset:1024 sc1
    buffer_load_dwordx4 v[136:139], v11, s[24:27], s33 offen offset:0 sc1
    buffer_load_dwordx4 v[140:143], v11, s[24:27], s33 offen offset:1024 sc1
    s_add_u32 s33, s33, 16384
L_dnp_skip:
    s_cmp_lg_u32 s70, 0
    s_cbranch_scc1 L_b2_join
    s_mov_b64 exec, 1
    s_mov_b32 s12, 0
    s_movk_i32 s13, 16
L_b2_poll:
    global_load_dword v5, v7, s[80:81] sc1
    s_add_u32 s12, s12, 1
    s_waitcnt vmcnt(0)
    v_cmp_gt_u32 vcc, s13, v5
    s_cmp_gt_u32 s12, 0x400000
    s_cbranch_scc1 L_b2_to
    s_cbranch_vccnz L_b2_poll
L_b2_to:
    s_mov_b64 exec, -1
L_b2_join:
    s_barrier
    s_lshl_b32 s3, s74, 1
    s_lshr_b32 s4, s75, 3
    s_add_u32 s3, s3, s4
    s_and_b32 s4, s75, 7
    v_and_b32 v6, 63, v0
    v_lshlrev_b32 v7, 4, v6
    s_mul_i32 s6, s3, 43
    s_add_u32 s5, s70, 24
    s_cmp_lt_u32 s70, 4
    s_cselect_b32 s5, s70, s5
    s_add_u32 s6, s6, s5
    s_lshl_b32 s6, s6, 12
    s_add_u32 s6, s6, s68
    s_lshr_b32 s5, s70, 1
    s_add_u32 s8, s5, 0
    s_and_b32 s8, s8, 3
    s_lshl_b32 s8, s8, 10
    v_add_u32 v12, s8, v7
    s_add_u32 s8, s5, 1
    s_and_b32 s8, s8, 3
    s_lshl_b32 s8, s8, 10
    v_add_u32 v13, s8, v7
    s_add_u32 s8, s5, 2
    s_and_b32 s8, s8, 3
    s_lshl_b32 s8, s8, 10
    v_add_u32 v14, s8, v7
    s_add_u32 s8, s5, 3
    s_and_b32 s8, s8, 3
    s_lshl_b32 s8, s8, 10
    v_add_u32 v15, s8, v7
    buffer_load_dwordx4 v[192:195], v12, s[24:27], s6 offen sc1
    buffer_load_dwordx4 v[196:199], v13, s[24:27], s6 offen sc1
    buffer_load_dwordx4 v[200:203], v14, s[24:27], s6 offen sc1
    buffer_load_dwordx4 v[204:207], v15, s[24:27], s6 offen sc1
    s_add_u32 s6, s6, 16384
    buffer_load_dwordx4 v[208:211], v12, s[24:27], s6 offen sc1
    buffer_load_dwordx4 v[212:215], v13, s[24:27], s6 offen sc1
    buffer_load_dwordx4 v[216:219], v14, s[24:27], s6 offen sc1
    buffer_load_dwordx4 v[220:223], v15, s[24:27], s6 offen sc1
    s_add_u32 s6, s6, 16384
    buffer_load_dwordx4 v[224:227], v12, s[24:27], s6 offen sc1
    buffer_load_dwordx4 v[228:231], v13, s[24:27], s6 offen sc1
    buffer_load_dwordx4 v[232:235], v14, s[24:27], s6 offen sc1
    buffer_load_dwordx4 v[236:239], v15, s[24:27], s6 offen sc1
    s_add_u32 s6, s6, 16384
    s_sub_u32 s8, s6, 16384
    s_cmp_eq_u32 s70, 7
    s_cselect_b32 s6, s8, s6
    buffer_load_dwordx4 v[240:243], v12, s[24:27], s6 offen sc1
    buffer_load_dwordx4 v[244:247], v13, s[24:27], s6 offen sc1
    buffer_load_dwordx4 v[248:251], v14, s[24:27], s6 offen sc1
    buffer_load_dwordx4 v[252:255], v15, s[24:27], s6 offen sc1
    s_add_u32 s6, s6, 16384
    s_cmp_ge_u32 s70, 4
    s_cbranch_scc1 L_md_short
    s_waitcnt vmcnt(12)
    v_mfma_f32_16x16x32_bf16 v[16:19], v[192:195], v[80:83], 0
    v_mfma_f32_16x16x32_bf16 v[20:23], v[192:195], v[84:87], 0
    v_mfma_f32_16x16x32_bf16 v[24:27], v[192:195], v[88:91], 0
    v_mfma_f32_16x16x32_bf16 v[28:31], v[192:195], v[92:95], 0
    v_mfma_f32_16x16x32_bf16 v[32:35], v[196:199], v[80:83], 0
    v_mfma_f32_16x16x32_bf16 v[36:39], v[196:199], v[84:87], 0
    v_mfma_f32_16x16x32_bf16 v[40:43], v[196:199], v[88:91], 0
    v_mfma_f32_16x16x32_bf16 v[44:47], v[196:199], v[92:95], 0
    v_mfma_f32_16x16x32_bf16 v[48:51], v[200:203], v[80:83], 0
    v_mfma_f32_16x16x32_bf16 v[52:55], v[200:203], v[84:87], 0
    v_mfma_f32_16x16x32_bf16 v[56:59], v[200:203], v[88:91], 0
    v_mfma_f32_16x16x32_bf16 v[60:63], v[200:203], v[92:95], 0
    v_mfma_f32_16x16x32_bf16 v[64:67], v[204:207], v[80:83], 0
    v_mfma_f32_16x16x32_bf16 v[68:71], v[204:207], v[84:87], 0
    v_mfma_f32_16x16x32_bf16 v[72:75], v[204:207], v[88:91], 0
    v_mfma_f32_16x16x32_bf16 v[76:79], v[204:207], v[92:95], 0
    buffer_load_dwordx4 v[192:195], v12, s[24:27], s6 offen sc1
    buffer_load_dwordx4 v[196:199], v13, s[24:27], s6 offen sc1
    buffer_load_dwordx4 v[200:203], v14, s[24:27], s6 offen sc1
    buffer_load_dwordx4 v[204:207], v15, s[24:27], s6 offen sc1
    s_add_u32 s6, s6, 16384
    s_waitcnt vmcnt(12)
    v_mfma_f32_16x16x32_bf16 v[16:19], v[208:211], v[96:99], v[16:19]
    v_mfma_f32_16x16x32_bf16 v[20:23], v[208:211], v[100:103], v[20:23]
    v_mfma_f32_16x16x32_bf16 v[24:27], v[208:211], v[104:107], v[24:27]
    v_mfma_f32_16x16x32_bf16 v[28:31], v[208:211], v[108:111], v[28:31]
    v_mfma_f32_16x16x32_bf16 v[32:35], v[212:215], v[96:99], v[32:35]
    v_mfma_f32_16x16x32_bf16 v[36:39], v[212:215], v[100:103], v[36:39]
    v_mfma_f32_16x16x32_bf16 v[40:43], v[212:215], v[104:107], v[40:43]
    v_mfma_f32_16x16x32_bf16 v[44:47], v[212:215], v[108:111], v[44:47]
    v_mfma_f32_16x16x32_bf16 v[48:51], v[216:219], v[96:99], v[48:51]
    v_mfma_f32_16x16x32_bf16 v[52:55], v[216:219], v[100:103], v[52:55]
    v_mfma_f32_16x16x32_bf16 v[56:59], v[216:219], v[104:107], v[56:59]
    v_mfma_f32_16x16x32_bf16 v[60:63], v[216:219], v[108:111], v[60:63]
    v_mfma_f32_16x16x32_bf16 v[64:67], v[220:223], v[96:99], v[64:67]
    v_mfma_f32_16x16x32_bf16 v[68:71], v[220:223], v[100:103], v[68:71]
    v_mfma_f32_16x16x32_bf16 v[72:75], v[220:223], v[104:107], v[72:75]
    v_mfma_f32_16x16x32_bf16 v[76:79], v[220:223], v[108:111], v[76:79]
    buffer_load_dwordx4 v[208:211], v12, s[24:27], s6 offen sc1
    buffer_load_dwordx4 v[212:215], v13, s[24:27], s6 offen sc1
    buffer_load_dwordx4 v[216:219], v14, s[24:27], s6 offen sc1
    buffer_load_dwordx4 v[220:223], v15, s[24:27], s6 offen sc1
    s_add_u32 s6, s6, 16384
    s_waitcnt vmcnt(12)
    v_mfma_f32_16x16x32_bf16 v[16:19], v[224:227], v[112:115], v[16:19]
    v_mfma_f32_16x16x32_bf16 v[20:23], v[224:227], v[116:119], v[20:23]
    v_mfma_f32_16x16x32_bf16 v[24:27], v[224:227], v[120:123], v[24:27]
    v_mfma_f32_16x16x32_bf16 v[28:31], v[224:227], v[124:127], v[28:31]
    v_mfma_f32_16x16x32_bf16 v[32:35], v[228:231], v[112:115], v[32:35]
    v_mfma_f32_16x16x32_bf16 v[36:39], v[228:231], v[116:119], v[36:39]
    v_mfma_f32_16x16x32_bf16 v[40:43], v[228:231], v[120:123], v[40:43]
    v_mfma_f32_16x16x32_bf16 v[44:47], v[228:231], v[124:127], v[44:47]
    v_mfma_f32_16x16x32_bf16 v[48:51], v[232:235], v[112:115], v[48:51]
    v_mfma_f32_16x16x32_bf16 v[52:55], v[232:235], v[116:119], v[52:55]
    v_mfma_f32_16x16x32_bf16 v[56:59], v[232:235], v[120:123], v[56:59]
    v_mfma_f32_16x16x32_bf16 v[60:63], v[232:235], v[124:127], v[60:63]
    v_mfma_f32_16x16x32_bf16 v[64:67], v[236:239], v[112:115], v[64:67]
    v_mfma_f32_16x16x32_bf16 v[68:71], v[236:239], v[116:119], v[68:71]
    v_mfma_f32_16x16x32_bf16 v[72:75], v[236:239], v[120:123], v[72:75]
    v_mfma_f32_16x16x32_bf16 v[76:79], v[236:239], v[124:127], v[76:79]
    buffer_load_dwordx4 v[224:227], v12, s[24:27], s6 offen sc1
    buffer_load_dwordx4 v[228:231], v13, s[24:27], s6 offen sc1
    buffer_load_dwordx4 v[232:235], v14, s[24:27], s6 offen sc1
    buffer_load_dwordx4 v[236:239], v15, s[24:27], s6 offen sc1
    s_add_u32 s6, s6, 16384
    s_lshl_b32 s8, s4, 6
    s_and_b32 s9, s70, 1
    s_lshl_b32 s9, s9, 5
    s_add_u32 s8, s8, s9
    v_and_b32 v10, 15, v6
    v_add_u32 v10, s8, v10
    v_lshlrev_b32 v10, 12, v10
    v_lshrrev_b32 v11, 4, v6
    v_lshl_add_u32 v10, v11, 3, v10
    s_lshl_b32 s8, s3, 7
    s_lshl_b32 s9, s5, 5
    s_add_u32 s8, s8, s9
    s_add_u32 s8, s8, s67
    s_add_u32 s9, s8, 65536
    buffer_load_dwordx2 v[2:3], v10, s[24:27], s8 offen sc1
    buffer_load_dwordx2 v[4:5], v10, s[24:27], s9 offen sc1
    s_waitcnt vmcnt(12)
    v_mfma_f32_16x16x32_bf16 v[16:19], v[240:243], v[128:131], v[16:19]
    v_mfma_f32_16x16x32_bf16 v[20:23], v[240:243], v[132:135], v[20:23]
    v_mfma_f32_16x16x32_bf16 v[24:27], v[240:243], v[136:139], v[24:27]
    v_mfma_f32_16x16x32_bf16 v[28:31], v[240:243], v[140:143], v[28:31]
    v_mfma_f32_16x16x32_bf16 v[32:35], v[244:247], v[128:131], v[32:35]
    v_mfma_f32_16x16x32_bf16 v[36:39], v[244:247], v[132:135], v[36:39]
    v_mfma_f32_16x16x32_bf16 v[40:43], v[244:247], v[136:139], v[40:43]
    v_mfma_f32_16x16x32_bf16 v[44:47], v[244:247], v[140:143], v[44:47]
    v_mfma_f32_16x16x32_bf16 v[48:51], v[248:251], v[128:131], v[48:51]
    v_mfma_f32_16x16x32_bf16 v[52:55], v[248:251], v[132:135], v[52:55]
    v_mfma_f32_16x16x32_bf16 v[56:59], v[248:251], v[136:139], v[56:59]
    v_mfma_f32_16x16x32_bf16 v[60:63], v[248:251], v[140:143], v[60:63]
    v_mfma_f32_16x16x32_bf16 v[64:67], v[252:255], v[128:131], v[64:67]
    v_mfma_f32_16x16x32_bf16 v[68:71], v[252:255], v[132:135], v[68:71]
    v_mfma_f32_16x16x32_bf16 v[72:75], v[252:255], v[136:139], v[72:75]
    v_mfma_f32_16x16x32_bf16 v[76:79], v[252:255], v[140:143], v[76:79]
    s_waitcnt vmcnt(10)
    v_mfma_f32_16x16x32_bf16 v[16:19], v[192:195], v[144:147], v[16:19]
    v_mfma_f32_16x16x32_bf16 v[20:23], v[192:195], v[148:151], v[20:23]
    v_mfma_f32_16x16x32_bf16 v[24:27], v[192:195], v[152:155], v[24:27]
    v_mfma_f32_16x16x32_bf16 v[28:31], v[192:195], v[156:159], v[28:31]
    v_mfma_f32_16x16x32_bf16 v[32:35], v[196:199], v[144:147], v[32:35]
    v_mfma_f32_16x16x32_bf16 v[36:39], v[196:199], v[148:151], v[36:39]
    v_mfma_f32_16x16x32_bf16 v[40:43], v[196:199], v[152:155], v[40:43]
    v_mfma_f32_16x16x32_bf16 v[44:47], v[196:199], v[156:159], v[44:47]
    v_mfma_f32_16x16x32_bf16 v[48:51], v[200:203], v[144:147], v[48:51]
    v_mfma_f32_16x16x32_bf16 v[52:55], v[200:203], v[148:151], v[52:55]
    v_mfma_f32_16x16x32_bf16 v[56:59], v[200:203], v[152:155], v[56:59]
    v_mfma_f32_16x16x32_bf16 v[60:63], v[200:203], v[156:159], v[60:63]
    v_mfma_f32_16x16x32_bf16 v[64:67], v[204:207], v[144:147], v[64:67]
    v_mfma_f32_16x16x32_bf16 v[68:71], v[204:207], v[148:151], v[68:71]
    v_mfma_f32_16x16x32_bf16 v[72:75], v[204:207], v[152:155], v[72:75]
    v_mfma_f32_16x16x32_bf16 v[76:79], v[204:207], v[156:159], v[76:79]
    s_waitcnt vmcnt(6)
    v_mfma_f32_16x16x32_bf16 v[16:19], v[208:211], v[160:163], v[16:19]
    v_mfma_f32_16x16x32_bf16 v[20:23], v[208:211], v[164:167], v[20:23]
    v_mfma_f32_16x16x32_bf16 v[24:27], v[208:211], v[168:171], v[24:27]
    v_mfma_f32_16x16x32_bf16 v[28:31], v[208:211], v[172:175], v[28:31]
    v_mfma_f32_16x16x32_bf16 v[32:35], v[212:215], v[160:163], v[32:35]
    v_mfma_f32_16x16x32_bf16 v[36:39], v[212:215], v[164:167], v[36:39]
    v_mfma_f32_16x16x32_bf16 v[40:43], v[212:215], v[168:171], v[40:43]
    v_mfma_f32_16x16x32_bf16 v[44:47], v[212:215], v[172:175], v[44:47]
    v_mfma_f32_16x16x32_bf16 v[48:51], v[216:219], v[160:163], v[48:51]
    v_mfma_f32_16x16x32_bf16 v[52:55], v[216:219], v[164:167], v[52:55]
    v_mfma_f32_16x16x32_bf16 v[56:59], v[216:219], v[168:171], v[56:59]
    v_mfma_f32_16x16x32_bf16 v[60:63], v[216:219], v[172:175], v[60:63]
    v_mfma_f32_16x16x32_bf16 v[64:67], v[220:223], v[160:163], v[64:67]
    v_mfma_f32_16x16x32_bf16 v[68:71], v[220:223], v[164:167], v[68:71]
    v_mfma_f32_16x16x32_bf16 v[72:75], v[220:223], v[168:171], v[72:75]
    v_mfma_f32_16x16x32_bf16 v[76:79], v[220:223], v[172:175], v[76:79]
    s_waitcnt vmcnt(2)
    v_mfma_f32_16x16x32_bf16 v[16:19], v[224:227], v[176:179], v[16:19]
    v_mfma_f32_16x16x32_bf16 v[20:23], v[224:227], v[180:183], v[20:23]
    v_mfma_f32_16x16x32_bf16 v[24:27], v[224:227], v[184:187], v[24:27]
    v_mfma_f32_16x16x32_bf16 v[28:31], v[224:227], v[188:191], v[28:31]
    v_mfma_f32_16x16x32_bf16 v[32:35], v[228:231], v[176:179], v[32:35]
    v_mfma_f32_16x16x32_bf16 v[36:39], v[228:231], v[180:183], v[36:39]
    v_mfma_f32_16x16x32_bf16 v[40:43], v[228:231], v[184:187], v[40:43]
    v_mfma_f32_16x16x32_bf16 v[44:47], v[228:231], v[188:191], v[44:47]
    v_mfma_f32_16x16x32_bf16 v[48:51], v[232:235], v[176:179], v[48:51]
    v_mfma_f32_16x16x32_bf16 v[52:55], v[232:235], v[180:183], v[52:55]
    v_mfma_f32_16x16x32_bf16 v[56:59], v[232:235], v[184:187], v[56:59]
    v_mfma_f32_16x16x32_bf16 v[60:63], v[232:235], v[188:191], v[60:63]
    v_mfma_f32_16x16x32_bf16 v[64:67], v[236:239], v[176:179], v[64:67]
    v_mfma_f32_16x16x32_bf16 v[68:71], v[236:239], v[180:183], v[68:71]
    v_mfma_f32_16x16x32_bf16 v[72:75], v[236:239], v[184:187], v[72:75]
    v_mfma_f32_16x16x32_bf16 v[76:79], v[236:239], v[188:191], v[76:79]
    s_branch L_md_skip
L_md_short:
    s_lshl_b32 s8, s4, 6
    s_and_b32 s9, s70, 1
    s_lshl_b32 s9, s9, 5
    s_add_u32 s8, s8, s9
    v_and_b32 v10, 15, v6
    v_add_u32 v10, s8, v10
    v_lshlrev_b32 v10, 12, v10
    v_lshrrev_b32 v11, 4, v6
    v_lshl_add_u32 v10, v11, 3, v10
    s_lshl_b32 s8, s3, 7
    s_lshl_b32 s9, s5, 5
    s_add_u32 s8, s8, s9
    s_add_u32 s8, s8, s67
    s_add_u32 s9, s8, 65536
    buffer_load_dwordx2 v[2:3], v10, s[24:27], s8 offen sc1
    buffer_load_dwordx2 v[4:5], v10, s[24:27], s9 offen sc1
    s_waitcnt vmcnt(14)
    v_mfma_f32_16x16x32_bf16 v[16:19], v[192:195], v[80:83], 0
    v_mfma_f32_16x16x32_bf16 v[20:23], v[192:195], v[84:87], 0
    v_mfma_f32_16x16x32_bf16 v[24:27], v[192:195], v[88:91], 0
    v_mfma_f32_16x16x32_bf16 v[28:31], v[192:195], v[92:95], 0
    v_mfma_f32_16x16x32_bf16 v[32:35], v[196:199], v[80:83], 0
    v_mfma_f32_16x16x32_bf16 v[36:39], v[196:199], v[84:87], 0
    v_mfma_f32_16x16x32_bf16 v[40:43], v[196:199], v[88:91], 0
    v_mfma_f32_16x16x32_bf16 v[44:47], v[196:199], v[92:95], 0
    v_mfma_f32_16x16x32_bf16 v[48:51], v[200:203], v[80:83], 0
    v_mfma_f32_16x16x32_bf16 v[52:55], v[200:203], v[84:87], 0
    v_mfma_f32_16x16x32_bf16 v[56:59], v[200:203], v[88:91], 0
    v_mfma_f32_16x16x32_bf16 v[60:63], v[200:203], v[92:95], 0
    v_mfma_f32_16x16x32_bf16 v[64:67], v[204:207], v[80:83], 0
    v_mfma_f32_16x16x32_bf16 v[68:71], v[204:207], v[84:87], 0
    v_mfma_f32_16x16x32_bf16 v[72:75], v[204:207], v[88:91], 0
    v_mfma_f32_16x16x32_bf16 v[76:79], v[204:207], v[92:95], 0
    s_waitcnt vmcnt(10)
    v_mfma_f32_16x16x32_bf16 v[16:19], v[208:211], v[96:99], v[16:19]
    v_mfma_f32_16x16x32_bf16 v[20:23], v[208:211], v[100:103], v[20:23]
    v_mfma_f32_16x16x32_bf16 v[24:27], v[208:211], v[104:107], v[24:27]
    v_mfma_f32_16x16x32_bf16 v[28:31], v[208:211], v[108:111], v[28:31]
    v_mfma_f32_16x16x32_bf16 v[32:35], v[212:215], v[96:99], v[32:35]
    v_mfma_f32_16x16x32_bf16 v[36:39], v[212:215], v[100:103], v[36:39]
    v_mfma_f32_16x16x32_bf16 v[40:43], v[212:215], v[104:107], v[40:43]
    v_mfma_f32_16x16x32_bf16 v[44:47], v[212:215], v[108:111], v[44:47]
    v_mfma_f32_16x16x32_bf16 v[48:51], v[216:219], v[96:99], v[48:51]
    v_mfma_f32_16x16x32_bf16 v[52:55], v[216:219], v[100:103], v[52:55]
    v_mfma_f32_16x16x32_bf16 v[56:59], v[216:219], v[104:107], v[56:59]
    v_mfma_f32_16x16x32_bf16 v[60:63], v[216:219], v[108:111], v[60:63]
    v_mfma_f32_16x16x32_bf16 v[64:67], v[220:223], v[96:99], v[64:67]
    v_mfma_f32_16x16x32_bf16 v[68:71], v[220:223], v[100:103], v[68:71]
    v_mfma_f32_16x16x32_bf16 v[72:75], v[220:223], v[104:107], v[72:75]
    v_mfma_f32_16x16x32_bf16 v[76:79], v[220:223], v[108:111], v[76:79]
    s_waitcnt vmcnt(6)
    v_mfma_f32_16x16x32_bf16 v[16:19], v[224:227], v[112:115], v[16:19]
    v_mfma_f32_16x16x32_bf16 v[20:23], v[224:227], v[116:119], v[20:23]
    v_mfma_f32_16x16x32_bf16 v[24:27], v[224:227], v[120:123], v[24:27]
    v_mfma_f32_16x16x32_bf16 v[28:31], v[224:227], v[124:127], v[28:31]
    v_mfma_f32_16x16x32_bf16 v[32:35], v[228:231], v[112:115], v[32:35]
    v_mfma_f32_16x16x32_bf16 v[36:39], v[228:231], v[116:119], v[36:39]
    v_mfma_f32_16x16x32_bf16 v[40:43], v[228:231], v[120:123], v[40:43]
    v_mfma_f32_16x16x32_bf16 v[44:47], v[228:231], v[124:127], v[44:47]
    v_mfma_f32_16x16x32_bf16 v[48:51], v[232:235], v[112:115], v[48:51]
    v_mfma_f32_16x16x32_bf16 v[52:55], v[232:235], v[116:119], v[52:55]
    v_mfma_f32_16x16x32_bf16 v[56:59], v[232:235], v[120:123], v[56:59]
    v_mfma_f32_16x16x32_bf16 v[60:63], v[232:235], v[124:127], v[60:63]
    v_mfma_f32_16x16x32_bf16 v[64:67], v[236:239], v[112:115], v[64:67]
    v_mfma_f32_16x16x32_bf16 v[68:71], v[236:239], v[116:119], v[68:71]
    v_mfma_f32_16x16x32_bf16 v[72:75], v[236:239], v[120:123], v[72:75]
    v_mfma_f32_16x16x32_bf16 v[76:79], v[236:239], v[124:127], v[76:79]
    s_waitcnt vmcnt(2)
    s_cmp_eq_u32 s70, 7
    s_cbranch_scc1 L_md_skip
    v_mfma_f32_16x16x32_bf16 v[16:19], v[240:243], v[128:131], v[16:19]
    v_mfma_f32_16x16x32_bf16 v[20:23], v[240:243], v[132:135], v[20:23]
    v_mfma_f32_16x16x32_bf16 v[24:27], v[240:243], v[136:139], v[24:27]
    v_mfma_f32_16x16x32_bf16 v[28:31], v[240:243], v[140:143], v[28:31]
    v_mfma_f32_16x16x32_bf16 v[32:35], v[244:247], v[128:131], v[32:35]
    v_mfma_f32_16x16x32_bf16 v[36:39], v[244:247], v[132:135], v[36:39]
    v_mfma_f32_16x16x32_bf16 v[40:43], v[244:247], v[136:139], v[40:43]
    v_mfma_f32_16x16x32_bf16 v[44:47], v[244:247], v[140:143], v[44:47]
    v_mfma_f32_16x16x32_bf16 v[48:51], v[248:251], v[128:131], v[48:51]
    v_mfma_f32_16x16x32_bf16 v[52:55], v[248:251], v[132:135], v[52:55]
    v_mfma_f32_16x16x32_bf16 v[56:59], v[248:251], v[136:139], v[56:59]
    v_mfma_f32_16x16x32_bf16 v[60:63], v[248:251], v[140:143], v[60:63]
    v_mfma_f32_16x16x32_bf16 v[64:67], v[252:255], v[128:131], v[64:67]
    v_mfma_f32_16x16x32_bf16 v[68:71], v[252:255], v[132:135], v[68:71]
    v_mfma_f32_16x16x32_bf16 v[72:75], v[252:255], v[136:139], v[72:75]
    v_mfma_f32_16x16x32_bf16 v[76:79], v[252:255], v[140:143], v[76:79]
L_md_skip:
    s_and_b32 s9, s70, 1
    s_add_u32 s8, s5, 0
    s_and_b32 s8, s8, 3
    s_lshl_b32 s8, s8, 1
    s_xor_b32 s10, s9, 1
    s_add_u32 s8, s8, s10
    s_mul_i32 s8, s8, 14336
    s_add_u32 s8, s8, 43008
    v_add_u32 v8, s8, v7
    ds_write_b128 v8, v[24:27]
    ds_write_b128 v8, v[28:31] offset:1024
    s_add_u32 s8, s5, 1
    s_and_b32 s8, s8, 3
    s_lshl_b32 s8, s8, 1
    s_xor_b32 s10, s9, 0
    s_add_u32 s8, s8, s10
    s_mul_i32 s8, s8, 14336
    s_add_u32 s8, s8, 45056
    v_add_u32 v8, s8, v7
    ds_write_b128 v8, v[32:35]
    ds_write_b128 v8, v[36:39] offset:1024
    s_add_u32 s8, s5, 1
    s_and_b32 s8, s8, 3
    s_lshl_b32 s8, s8, 1
    s_xor_b32 s10, s9, 1
    s_add_u32 s8, s8, s10
    s_mul_i32 s8, s8, 14336
    s_add_u32 s8, s8, 47104
    v_add_u32 v8, s8, v7
    ds_write_b128 v8, v[40:43]
    ds_write_b128 v8, v[44:47] offset:1024
    s_add_u32 s8, s5, 2
    s_and_b32 s8, s8, 3
    s_lshl_b32 s8, s8, 1
    s_xor_b32 s10, s9, 0
    s_add_u32 s8, s8, s10
    s_mul_i32 s8, s8, 14336
    s_add_u32 s8, s8, 49152
    v_add_u32 v8, s8, v7
    ds_write_b128 v8, v[48:51]
    ds_write_b128 v8, v[52:55] offset:1024
    s_add_u32 s8, s5, 2
    s_and_b32 s8, s8, 3
    s_lshl_b32 s8, s8, 1
    s_xor_b32 s10, s9, 1
    s_add_u32 s8, s8, s10
    s_mul_i32 s8, s8, 14336
    s_add_u32 s8, s8, 51200
    v_add_u32 v8, s8, v7
    ds_write_b128 v8, v[56:59]
    ds_write_b128 v8, v[60:63] offset:1024
    s_add_u32 s8, s5, 3
    s_and_b32 s8, s8, 3
    s_lshl_b32 s8, s8, 1
    s_xor_b32 s10, s9, 0
    s_add_u32 s8, s8, s10
    s_mul_i32 s8, s8, 14336
    s_add_u32 s8, s8, 53248
    v_add_u32 v8, s8, v7
    ds_write_b128 v8, v[64:67]
    ds_write_b128 v8, v[68:71] offset:1024
    s_add_u32 s8, s5, 3
    s_and_b32 s8, s8, 3
    s_lshl_b32 s8, s8, 1
    s_xor_b32 s10, s9, 1
    s_add_u32 s8, s8, s10
    s_mul_i32 s8, s8, 14336
    s_add_u32 s8, s8, 55296
    v_add_u32 v8, s8, v7
    ds_write_b128 v8, v[72:75]
    ds_write_b128 v8, v[76:79] offset:1024
    s_mul_i32 s8, s70, 14336
    s_add_u32 s8, s8, 43008
    v_add_u32 v8, s8, v7
    v_and_b32 v10, 15, v6
    s_lshl_b32 s10, s9, 5
    v_add_u32 v10, s10, v10
    v_mul_u32_u24 v10, 144, v10
    v_lshrrev_b32 v11, 4, v6
    v_lshl_add_u32 v10, v11, 3, v10
    s_lshl_b32 s10, s5, 5
    s_add_u32 s10, s10, 33792
    v_add_u32 v10, s10, v10
    s_waitcnt lgkmcnt(0)
    s_barrier
    ds_read_b128 v[80:83], v8 offset:0
    ds_read_b128 v[84:87], v8 offset:1024
    ds_read_b128 v[88:91], v8 offset:2048
    ds_read_b128 v[92:95], v8 offset:3072
    ds_read_b128 v[96:99], v8 offset:4096
    ds_read_b128 v[100:103], v8 offset:5120
    ds_read_b128 v[104:107], v8 offset:6144
    ds_read_b128 v[108:111], v8 offset:7168
    ds_read_b128 v[112:115], v8 offset:8192
    ds_read_b128 v[116:119], v8 offset:9216
    ds_read_b128 v[120:123], v8 offset:10240
    ds_read_b128 v[124:127], v8 offset:11264
    ds_read_b128 v[128:131], v8 offset:12288
    ds_read_b128 v[132:135], v8 offset:13312
    s_waitcnt vmcnt(0)
    v_lshlrev_b32 v32, 16, v2
    v_and_b32 v33, 0xffff0000, v2
    v_lshlrev_b32 v34, 16, v3
    v_and_b32 v35, 0xffff0000, v3
    v_lshlrev_b32 v36, 16, v4
    v_and_b32 v37, 0xffff0000, v4
    v_lshlrev_b32 v38, 16, v5
    v_and_b32 v39, 0xffff0000, v5
    v_add_f32 v16, v16, v32
    v_add_f32 v17, v17, v33
    v_add_f32 v18, v18, v34
    v_add_f32 v19, v19, v35
    v_add_f32 v20, v20, v36
    v_add_f32 v21, v21, v37
    v_add_f32 v22, v22, v38
    v_add_f32 v23, v23, v39
    s_waitcnt lgkmcnt(12)
    v_add_f32 v16, v16, v80
    v_add_f32 v17, v17, v81
    v_add_f32 v18, v18, v82
    v_add_f32 v19, v19, v83
    v_add_f32 v20, v20, v84
    v_add_f32 v21, v21, v85
    v_add_f32 v22, v22, v86
    v_add_f32 v23, v23, v87
    s_waitcnt lgkmcnt(10)
    v_add_f32 v16, v16, v88
    v_add_f32 v17, v17, v89
    v_add_f32 v18, v18, v90
    v_add_f32 v19, v19, v91
    v_add_f32 v20, v20, v92
    v_add_f32 v21, v21, v93
    v_add_f32 v22, v22, v94
    v_add_f32 v23, v23, v95
    s_waitcnt lgkmcnt(8)
    v_add_f32 v16, v16, v96
    v_add_f32 v17, v17, v97
    v_add_f32 v18, v18, v98
    v_add_f32 v19, v19, v99
    v_add_f32 v20, v20, v100
    v_add_f32 v21, v21, v101
    v_add_f32 v22, v22, v102
    v_add_f32 v23, v23, v103
    s_waitcnt lgkmcnt(6)
    v_add_f32 v16, v16, v104
    v_add_f32 v17, v17, v105
    v_add_f32 v18, v18, v106
    v_add_f32 v19, v19, v107
    v_add_f32 v20, v20, v108
    v_add_f32 v21, v21, v109
    v_add_f32 v22, v22, v110
    v_add_f32 v23, v23, v111
    s_waitcnt lgkmcnt(4)
    v_add_f32 v16, v16, v112
    v_add_f32 v17, v17, v113
    v_add_f32 v18, v18, v114
    v_add_f32 v19, v19, v115
    v_add_f32 v20, v20, v116
    v_add_f32 v21, v21, v117
    v_add_f32 v22, v22, v118
    v_add_f32 v23, v23, v119
    s_waitcnt lgkmcnt(2)
    v_add_f32 v16, v16, v120
    v_add_f32 v17, v17, v121
    v_add_f32 v18, v18, v122
    v_add_f32 v19, v19, v123
    v_add_f32 v20, v20, v124
    v_add_f32 v21, v21, v125
    v_add_f32 v22, v22, v126
    v_add_f32 v23, v23, v127
    s_waitcnt lgkmcnt(0)
    v_add_f32 v16, v16, v128
    v_add_f32 v17, v17, v129
    v_add_f32 v18, v18, v130
    v_add_f32 v19, v19, v131
    v_add_f32 v20, v20, v132
    v_add_f32 v21, v21, v133
    v_add_f32 v22, v22, v134
    v_add_f32 v23, v23, v135
    v_cvt_pk_bf16_f32 v32, v16, v17
    v_cvt_pk_bf16_f32 v33, v18, v19
    v_cvt_pk_bf16_f32 v34, v20, v21
    v_cvt_pk_bf16_f32 v35, v22, v23
    ds_write_b64 v10, v[32:33]
    ds_write_b64 v10, v[34:35] offset:2304
    s_cmp_eq_u32 s64, 1
    s_cbranch_scc1 L_md_final
    v_lshrrev_b32 v8, 3, v0
    v_and_b32 v9, 7, v0
    v_mul_u32_u24 v10, 144, v8
    v_lshl_add_u32 v10, v9, 4, v10
    s_lshl_b32 s8, s4, 6
    v_add_u32 v8, s8, v8
    v_lshlrev_b32 v8, 12, v8
    v_lshl_add_u32 v8, v9, 4, v8
    s_lshl_b32 s8, s3, 7
    s_add_u32 s8, s8, 4194304
    v_lshrrev_b32 v3, 4, v6
    v_bfe_u32 v9, v6, 2, 2
    v_lshl_add_u32 v3, v3, 2, v9
    v_mul_u32_u24 v3, 144, v3
    v_and_b32 v9, 3, v6
    v_lshl_add_u32 v3, v9, 3, v3
    s_and_b32 s10, s70, 3
    s_lshl_b32 s10, s10, 5
    v_add_u32 v3, s10, v3
    v_mov_b32 v40, 0x3f803f80
    v_mov_b32 v41, 0x3f803f80
    v_mov_b32 v42, 0x3f803f80
    v_mov_b32 v43, 0x3f803f80
    s_waitcnt lgkmcnt(0)
    s_barrier
    ds_read_b128 v[32:35], v10 offset:33792
    ds_read_b64_tr_b16 v[16:17], v3 offset:33792
    ds_read_b64_tr_b16 v[18:19], v3 offset:36096
    ds_read_b64_tr_b16 v[20:21], v3 offset:38400
    ds_read_b64_tr_b16 v[22:23], v3 offset:40704
    s_waitcnt lgkmcnt(4)
    buffer_store_dwordx4 v[32:35], v8, s[24:27], s8 offen sc1
    s_waitcnt lgkmcnt(0)
    s_cmp_ge_u32 s70, 4
    s_cbranch_scc1 L_md_done
    v_mfma_f32_16x16x32_bf16 v[24:27], v[16:19], v[16:19], 0
    v_mfma_f32_16x16x32_bf16 v[28:31], v[40:43], v[16:19], 0
    v_mfma_f32_16x16x32_bf16 v[24:27], v[20:23], v[20:23], v[24:27]
    v_mfma_f32_16x16x32_bf16 v[28:31], v[40:43], v[20:23], v[28:31]
    v_cmp_eq_u32 vcc, 1, v9
    v_cmp_eq_u32 s[10:11], 2, v9
    v_cmp_eq_u32 s[12:13], 3, v9
    v_bfe_u32 v3, v6, 2, 2
    v_lshrrev_b32 v8, 4, v6
    v_cmp_eq_u32 s[14:15], v3, v8
    v_and_b32 v3, 15, v6
    s_lshl_b32 s8, s70, 4
    s_lshl_b32 s9, s3, 6
    s_add_u32 s8, s8, s9
    v_add_u32 v3, s8, v3
    v_lshlrev_b32 v3, 2, v3
    s_mov_b32 s9, 8454144
    s_mov_b32 s8, 8462336
    v_cndmask_b32 v24, v24, v25, vcc
    v_cndmask_b32 v24, v24, v26, s[10:11]
    v_cndmask_b32 v24, v24, v27, s[12:13]
    s_mov_b64 exec, s[14:15]
    buffer_atomic_add_f32 v28, v3, s[24:27], s9 offen sc0 sc1
    buffer_atomic_add_f32 v24, v3, s[24:27], s8 offen sc0 sc1
    s_mov_b64 exec, -1
    s_branch L_md_done
L_md_final:
    v_lshrrev_b32 v3, 4, v6
    v_bfe_u32 v9, v6, 2, 2
    v_lshl_add_u32 v3, v3, 3, v9
    s_lshr_b32 s10, s70, 2
    s_lshl_b32 s10, s10, 5
    v_add_u32 v3, s10, v3
    v_mul_u32_u24 v3, 144, v3
    v_and_b32 v9, 3, v6
    v_lshl_add_u32 v3, v9, 3, v3
    s_and_b32 s11, s70, 3
    s_lshl_b32 s12, s11, 5
    v_add_u32 v3, s12, v3
    v_and_b32 v8, 15, v6
    s_lshl_b32 s11, s11, 4
    s_lshl_b32 s9, s3, 6
    s_add_u32 s11, s11, s9
    v_add_u32 v8, s11, v8
    v_lshlrev_b32 v8, 10, v8
    v_lshrrev_b32 v9, 4, v6
    v_lshl_add_u32 v8, v9, 4, v8
    s_lshl_b32 s8, s4, 7
    s_lshl_b32 s10, s10, 1
    s_add_u32 s8, s8, s10
    s_waitcnt lgkmcnt(0)
    s_barrier
    ds_read_b64_tr_b16 v[16:17], v3 offset:33792
    ds_read_b64_tr_b16 v[18:19], v3 offset:34368
    s_waitcnt lgkmcnt(0)
    buffer_store_dwordx4 v[16:19], v8, s[76:79], s8 offen
    s_endpgm
L_md_done:
    s_waitcnt vmcnt(0)
    s_barrier
    s_cmp_lg_u32 s70, 0
    s_cbranch_scc1 L_b3_nosig
    s_add_u32 s11, s69, 8192
    v_and_b32 v1, 63, v0
    v_mov_b32 v2, 1
    s_and_b32 s12, s2, 15
    s_lshl_b32 s10, s12, 7
    s_add_u32 s10, s10, s11
    v_mov_b32 v3, s10
    s_mov_b64 exec, 1
    global_atomic_add v4, v3, v2, s[80:81] sc0 sc1
    s_mov_b64 exec, -1
    s_add_u32 s11, s11, 2048
    s_lshl_b32 s12, s12, 2
    s_add_u32 s12, s12, s11
    v_lshlrev_b32 v3, 7, v1
    v_add_u32 v3, s12, v3
    s_and_b32 s10, s2, 31
    s_lshl_b32 s10, s10, 7
    s_add_u32 s10, s10, s11
    v_lshlrev_b32 v7, 2, v1
    v_add_u32 v7, s10, v7
    s_waitcnt vmcnt(0)
    v_readfirstlane_b32 s10, v4
    s_cmp_lg_u32 s10, 15
    s_cbranch_scc1 L_b3_nolast
    s_mov_b64 exec, 0xffffffff
    global_store_dword v3, v2, s[80:81] sc1
    s_mov_b64 exec, -1
L_b3_nolast:
L_b3_nosig:
    s_cmp_lg_u32 s70, 0
    s_cbranch_scc1 L_b3_join
    s_mov_b64 exec, 65535
    s_mov_b32 s12, 0
    s_movk_i32 s13, 1
L_b3_poll:
    global_load_dword v5, v7, s[80:81] sc1
    s_add_u32 s12, s12, 1
    s_waitcnt vmcnt(0)
    v_cmp_gt_u32 vcc, s13, v5
    s_cmp_gt_u32 s12, 0x400000
    s_cbranch_scc1 L_b3_to
    s_cbranch_vccnz L_b3_poll
L_b3_to:
    s_mov_b64 exec, -1
L_b3_join:
    s_barrier
    s_mov_b32 s64, 1
    s_mov_b32 s65, 4194304
    s_mov_b32 s66, 8454144
    s_mov_b32 s67, 6291456
    s_mov_b32 s68, 25165824
    s_mov_b32 s69, 8601600
    s_branch L_mega_layer
L_mega_end:
    s_endpgm
.section .rodata,"a"
.p2align 6
.amdhsa_kernel mega_kernel
  .amdhsa_next_free_vgpr 256
  .amdhsa_next_free_sgpr 102
  .amdhsa_accum_offset 256
  .amdhsa_group_segment_fixed_size 0
  .amdhsa_kernarg_size 128
  .amdhsa_user_sgpr_count 2
  .amdhsa_user_sgpr_kernarg_segment_ptr 1
  .amdhsa_system_sgpr_workgroup_id_x 1
.end_amdhsa_kernel
```
